```python
import torch

def _softmax(x, axis=-1):
    return torch.softmax(x, dim=axis)
def _gelu(x):
    return torch.nn.functional.gelu(x, approximate="tanh")
def _silu(x):
    return torch.nn.functional.silu(x)
def _sigmoid(x):
    return torch.sigmoid(x)
def _layernorm(x, axis=-1, eps=1e-5):
    m = x.mean(dim=axis, keepdim=True)
    v = x.var(dim=axis, keepdim=True, unbiased=False)
    return (x - m) / torch.sqrt(v + eps)
def _scatter_add(tgt, idx, src, axis=0):
    return tgt.clone().index_add_(axis, idx, src)
def _segment_sum(src, seg, n):
    out = torch.zeros((n,) + src.shape[1:], dtype=src.dtype)
    return out.index_add_(0, seg, src)
def _pad(x, pw):
    flat = tuple(v for pair in reversed(pw) for v in pair)
    return torch.nn.functional.pad(x, flat)

kernel_name = 'concat_heads__sliding_block_cached__mha_block_cached__decode'

def setup_inputs():

    _w = (lambda a: (lambda t: t.to(torch.bfloat16) if t.is_floating_point() else t)(torch.as_tensor(a)))
    def _A_setup():
        B, Sq, D = 8, 1, 640
        Hq, Hkv, Sk, Dh = 32, 32, 4096, 128
        assert Hq % Hkv == 0, (Hq, Hkv)
        return {
            "x": _w((lambda *s: torch.randn(*s, dtype=torch.bfloat16) * 0.8)(B, Sq, D)),
            "k_cache": _w((lambda *s: torch.randn(*s, dtype=torch.bfloat16) * 1.6)(B, Hkv, Sk, Dh)),
            "v_cache": _w((lambda *s: torch.randn(*s, dtype=torch.bfloat16) * 0.2)(B, Hkv, Sk, Dh)),
            "wq": _w((lambda *s: torch.randn(*s, dtype=torch.bfloat16) * 1.6)(D, Hq * Dh) * (D ** -0.5)),
            "wo": _w((lambda *s: torch.randn(*s, dtype=torch.bfloat16) * 0.2)(Hq * Dh, D) * ((Hq * Dh) ** -0.5)),
        }
    _A_in = _A_setup()

    def _B_setup():
        B, Sq, D = 8, 1, 640
        H, Sk, Dh = 32, 4096, 128
        return {
            "x": _w((lambda *s: torch.randn(*s, dtype=torch.bfloat16) * 0.8)(B, Sq, D)),
            "k_cache": _w((lambda *s: torch.randn(*s, dtype=torch.bfloat16) * 1.6)(B, H, Sk, Dh)),
            "v_cache": _w((lambda *s: torch.randn(*s, dtype=torch.bfloat16) * 0.2)(B, H, Sk, Dh)),
            "wq": _w((lambda *s: torch.randn(*s, dtype=torch.bfloat16) * 1.6)(D, H * Dh) * (D ** -0.5)),
            "wo": _w((lambda *s: torch.randn(*s, dtype=torch.bfloat16) * 0.2)(H * Dh, D) * ((H * Dh) ** -0.5)),
        }
    _B_in = _B_setup()

    return {
        "A_x": _A_in["x"],
        "A_k_cache": _A_in["k_cache"],
        "A_v_cache": _A_in["v_cache"],
        "A_wq": _A_in["wq"],
        "A_wo": _A_in["wo"],
        "B_x": _B_in["x"],
        "B_k_cache": _B_in["k_cache"],
        "B_v_cache": _B_in["v_cache"],
        "B_wq": _B_in["wq"],
        "B_wo": _B_in["wo"],
    }

def reference(A_x, A_k_cache, A_v_cache, A_wq, A_wo, B_x, B_k_cache, B_v_cache, B_wq, B_wo):
    def _A_ref(x, k_cache, v_cache, wq, wo):
        B, Sq, D = x.shape
        Hq, Dh = 32, 128
        Hkv, Sk = k_cache.shape[1], k_cache.shape[2]
        W = min(4096, max(256, Sk // 4))
        rep = Hq // Hkv
        q = (lambda x, *d: x.permute(*d))((x @ wq).reshape(B, Sq, Hq, Dh), 0, 2, 1, 3)
        k = (lambda x, n, axis: torch.repeat_interleave(x, n, dim=axis))(k_cache[:, :, Sk - W:, :], rep, axis=1)
        v = (lambda x, n, axis: torch.repeat_interleave(x, n, dim=axis))(v_cache[:, :, Sk - W:, :], rep, axis=1)
        scores = torch.einsum("bhqd,bhkd->bhqk", q, k) * (Dh ** -0.5)
        p = _softmax(scores, axis=-1)
        o = torch.einsum("bhqk,bhkd->bhqd", p, v)
        return (lambda x, *d: x.permute(*d))(o, 0, 2, 1, 3).reshape(B, Sq, Hq * Dh) @ wo

    def _B_ref(x, k_cache, v_cache, wq, wo):
        B, Sq, D = x.shape
        H, Dh = 32, 128
        q = (lambda x, *d: x.permute(*d))((x @ wq).reshape(B, Sq, H, Dh), 0, 2, 1, 3)
        scores = torch.einsum("bhqd,bhkd->bhqk", q, k_cache) * (Dh ** -0.5)
        p = _softmax(scores, axis=-1)
        o = torch.einsum("bhqk,bhkd->bhqd", p, v_cache)
        return (lambda x, *d: x.permute(*d))(o, 0, 2, 1, 3).reshape(B, Sq, H * Dh) @ wo

    a = _A_ref(A_x, A_k_cache, A_v_cache, A_wq, A_wo)
    b = _B_ref(B_x, B_k_cache, B_v_cache, B_wq, B_wo)
    return torch.concatenate([a, b], axis=-1)
```

```asm
; @launch grid=(256,1,1) block=(512,1,1) lds=159232
.amdgcn_target "amdgcn-amd-amdhsa--gfx950"
.text
.globl concat_heads__sliding_block_cached__mha_block_cached__decode_kernel
.p2align 8
.type concat_heads__sliding_block_cached__mha_block_cached__decode_kernel,@function
concat_heads__sliding_block_cached__mha_block_cached__decode_kernel:
    s_cmp_ge_u32 s2, 256
    s_cbranch_scc1 L_end
    s_load_dwordx16 s[32:47], s[0:1], 0
    s_load_dwordx8 s[48:55], s[0:1], 64
    s_load_dwordx2 s[56:57], s[0:1], 96
    v_lshrrev_b32 v2, 6, v0
    v_and_b32 v64, 63, v0
    s_lshl_b32 s91, s2, 20
    v_readfirstlane_b32 s3, v2
    v_lshlrev_b32 v1, 4, v64
    s_mov_b32 s12, 786432
    s_mov_b32 s6, 1048576
    s_mov_b32 s7, 0x00020000
    s_mov_b32 s13, 52736
    s_cmp_lg_u32 s3, 7
    s_cbranch_scc1 L_ent2
    s_waitcnt lgkmcnt(0)
    s_add_u32 s4, s34, s91
    s_addc_u32 s5, s35, 0
L_ent1:
    s_mov_b32 m0, s13
    s_add_u32 s13, s13, 4096
    buffer_load_dwordx4 v1, s[4:7], s12 offen offset:0 nt lds
    buffer_load_dwordx4 v1, s[4:7], s12 offen offset:1024 nt lds
    buffer_load_dwordx4 v1, s[4:7], s12 offen offset:2048 nt lds
    buffer_load_dwordx4 v1, s[4:7], s12 offen offset:3072 nt lds
    s_add_u32 s12, s12, 4096
    s_cmp_lt_u32 s13, 69120
    s_cbranch_scc1 L_ent1
L_ent2:
    s_lshr_b32 s93, s2, 5
    s_and_b32 s94, s2, 31
    v_and_b32 v3, 15, v0
    v_bfe_u32 v4, v0, 4, 2
    s_lshr_b32 s92, s93, 1
    s_mul_i32 s92, s92, 160
    v_lshlrev_b32 v60, 5, v2
    v_lshl_add_u32 v60, v4, 3, v60
    v_add_u32 v60, s92, v60
    v_lshlrev_b32 v6, 13, v60
    v_lshl_add_u32 v6, v3, 4, v6
    v_mul_u32_u24 v61, 1280, v3
    v_lshl_add_u32 v61, v60, 1, v61
    s_lshl_b32 s99, s94, 8
    s_sub_u32 s90, 5242880, s99
    v_mov_b32 v82, 0
    v_mov_b32 v83, 1
    s_mov_b32 s100, 0x400000
    v_subrev_u32 v62, 16, v64
    v_cmp_gt_u32 vcc, 10, v62
    v_lshlrev_b32 v64, 2, v64
    s_bitcmp1_b32 s93, 0
    v_cndmask_b32 v63, 0, v62, vcc
    s_waitcnt lgkmcnt(0)
    s_cselect_b32 s24, s42, s32
    s_cselect_b32 s25, s43, s33
    s_cselect_b32 s20, s48, s38
    s_cselect_b32 s21, s49, s39
    s_mov_b32 s26, 10240
    s_mov_b32 s27, 0x00020000
    s_add_u32 s20, s20, s99
    s_addc_u32 s21, s21, 0
    s_mov_b32 s22, s90
    s_mov_b32 s23, 0x00020000
    s_cmp_ge_u32 s3, 5
    s_cbranch_scc1 L_nowq
    buffer_load_dwordx4 v[164:167], v61, s[24:27], 0 offen
    s_mov_b32 s96, 0
    buffer_load_dwordx4 v[84:87], v6, s[20:23], s96 offen nt
    s_mov_b32 s96, 8192
    buffer_load_dwordx4 v[88:91], v6, s[20:23], s96 offen nt
    s_mov_b32 s96, 16384
    buffer_load_dwordx4 v[92:95], v6, s[20:23], s96 offen nt
    s_mov_b32 s96, 24576
    buffer_load_dwordx4 v[96:99], v6, s[20:23], s96 offen nt
    s_mov_b32 s96, 32768
    buffer_load_dwordx4 v[100:103], v6, s[20:23], s96 offen nt
    s_mov_b32 s96, 40960
    buffer_load_dwordx4 v[104:107], v6, s[20:23], s96 offen nt
    s_mov_b32 s96, 49152
    buffer_load_dwordx4 v[108:111], v6, s[20:23], s96 offen nt
    s_mov_b32 s96, 57344
    buffer_load_dwordx4 v[112:115], v6, s[20:23], s96 offen nt
L_nowq:
    s_mov_b64 exec, 0x3fffffff
    ds_write_b32 v64, v63 offset:4416
    s_mov_b64 exec, -1
    s_waitcnt lgkmcnt(0)
    s_load_dword s80, s[56:57], 0
    s_barrier
    s_cmp_eq_u32 s3, 7
    s_cbranch_scc1 L_loader
    s_mov_b32 s72, s56
    s_mov_b32 s73, s57
    s_mov_b32 s74, 8388608
    s_mov_b32 s75, 0x00020000
    s_mov_b32 s76, s52
    s_mov_b32 s77, s53
    s_mov_b32 s78, 20480
    s_mov_b32 s79, 0x00020000
    s_cmp_lt_u32 s93, 2
    s_cselect_b32 s49, 4, 2
    s_sub_u32 s92, s93, 2
    s_cmp_lt_u32 s92, 2
    s_cselect_b32 s54, 4, 2
    s_add_u32 s82, s93, 8
    s_add_u32 s83, s93, 6
    s_waitcnt lgkmcnt(0)
    s_add_u32 s80, s80, 1
    s_mul_i32 s81, s80, 0x9e3779b1
    s_xor_b32 s81, s81, 0x5bd1e995
    v_mov_b32 v78, s80
    v_mov_b32 v79, s81
    s_mov_b32 s84, 0xffff0000
    s_mov_b32 s85, 0x3db504f3
    s_mov_b32 s86, 0x3fb8aa3b
    s_mov_b32 s87, 0x05040100
    s_mov_b32 s88, 0x07060302
    s_mov_b32 s98, 0
    s_cmp_lt_u32 s3, 4
    s_cselect_b32 s48, 0, 2
    v_mul_u32_u24 v5, 544, v2
    v_lshl_add_u32 v5, v3, 5, v5
    v_lshl_add_u32 v5, v4, 3, v5
    v_and_b32 v60, 7, v3
    v_lshlrev_b32 v81, 8, v60
    v_lshl_add_u32 v81, v4, 4, v81
    s_cmp_ge_u32 s3, 5
    s_cbranch_scc1 L_qwait
    v_lshlrev_b32 v72, 12, v2
    v_lshl_add_u32 v72, v3, 9, v72
    v_lshl_add_u32 v72, v4, 4, v72
    v_add_u32 v72, 134656, v72
    v_lshrrev_b32 v73, 1, v1
    v_lshl_add_u32 v73, v2, 9, v73
    v_add_u32 v73, 134656, v73
    s_lshl_b32 s91, s94, 16
    s_add_u32 s68, s91, 3145728
    s_and_b32 s91, s93, 1
    s_lshl_b32 s91, s91, 15
    s_lshr_b32 s92, s93, 1
    s_lshl_b32 s92, s92, 13
    s_add_u32 s91, s91, s92
    s_lshl_b32 s92, s3, 10
    s_add_u32 s91, s91, s92
    s_add_u32 s70, s91, s68
    s_add_u32 s71, s70, 4096
    s_lshl_b32 s92, s93, 10
    s_add_u32 s68, s68, s92
    s_lshl_b32 s92, s3, 8
    s_add_u32 s68, s68, s92
    s_add_u32 s69, s68, 32768
    v_lshlrev_b32 v74, 13, v4
    v_lshl_add_u32 v74, v3, 4, v74
    v_and_b32 v75, 7, v3
    v_lshlrev_b32 v75, 5, v75
    v_lshrrev_b32 v6, 3, v3
    v_lshl_add_u32 v6, v2, 1, v6
    v_lshl_add_u32 v75, v6, 1, v75
    v_and_b32 v60, 1, v4
    v_lshl_add_u32 v75, v60, 4, v75
    v_lshrrev_b32 v60, 1, v4
    v_lshl_add_u32 v75, v60, 8, v75
    s_waitcnt vmcnt(0)
    v_perm_b32 v116, v88, v84, s87
    v_perm_b32 v117, v96, v92, s87
    v_perm_b32 v118, v104, v100, s87
    v_perm_b32 v119, v112, v108, s87
    v_perm_b32 v120, v88, v84, s88
    v_perm_b32 v121, v96, v92, s88
    v_perm_b32 v122, v104, v100, s88
    v_perm_b32 v123, v112, v108, s88
    v_perm_b32 v124, v89, v85, s87
    v_perm_b32 v125, v97, v93, s87
    v_perm_b32 v126, v105, v101, s87
    v_perm_b32 v127, v113, v109, s87
    v_perm_b32 v128, v89, v85, s88
    v_perm_b32 v129, v97, v93, s88
    v_perm_b32 v130, v105, v101, s88
    v_perm_b32 v131, v113, v109, s88
    v_perm_b32 v132, v90, v86, s87
    v_perm_b32 v133, v98, v94, s87
    v_perm_b32 v134, v106, v102, s87
    v_perm_b32 v135, v114, v110, s87
    v_perm_b32 v136, v90, v86, s88
    v_perm_b32 v137, v98, v94, s88
    v_perm_b32 v138, v106, v102, s88
    v_perm_b32 v139, v114, v110, s88
    v_perm_b32 v140, v91, v87, s87
    v_perm_b32 v141, v99, v95, s87
    v_perm_b32 v142, v107, v103, s87
    v_perm_b32 v143, v115, v111, s87
    v_perm_b32 v144, v91, v87, s88
    v_perm_b32 v145, v99, v95, s88
    v_perm_b32 v146, v107, v103, s88
    v_perm_b32 v147, v115, v111, s88
    v_mfma_f32_16x16x32_bf16 v[8:11], v[116:119], v[164:167], 0
    v_mfma_f32_16x16x32_bf16 v[12:15], v[120:123], v[164:167], 0
    v_mfma_f32_16x16x32_bf16 v[16:19], v[124:127], v[164:167], 0
    v_mfma_f32_16x16x32_bf16 v[20:23], v[128:131], v[164:167], 0
    v_mfma_f32_16x16x32_bf16 v[24:27], v[132:135], v[164:167], 0
    v_mfma_f32_16x16x32_bf16 v[28:31], v[136:139], v[164:167], 0
    v_mfma_f32_16x16x32_bf16 v[32:35], v[140:143], v[164:167], 0
    v_mfma_f32_16x16x32_bf16 v[36:39], v[144:147], v[164:167], 0
    s_mov_b32 exec_lo, 0x00ff00ff
    s_mov_b32 exec_hi, 0x00ff00ff
    ds_write_b128 v72, v[8:11] offset:0
    ds_write_b128 v72, v[12:15] offset:64
    ds_write_b128 v72, v[16:19] offset:128
    ds_write_b128 v72, v[20:23] offset:192
    ds_write_b128 v72, v[24:27] offset:256
    ds_write_b128 v72, v[28:31] offset:320
    ds_write_b128 v72, v[32:35] offset:384
    ds_write_b128 v72, v[36:39] offset:448
    s_waitcnt lgkmcnt(0)
    s_mov_b64 exec, 1
    ds_add_u32 v82, v83 offset:4428
    s_mov_b64 exec, -1
    s_cmp_eq_u32 s3, 4
    s_cbranch_scc1 L_qwait
L_sp1:
    ds_read_b32 v60, v82 offset:4428
    s_waitcnt lgkmcnt(0)
    v_readfirstlane_b32 s91, v60
    s_nop 0
    s_cmp_ge_u32 s91, 5
    s_cbranch_scc1 L_sp1d
    s_sleep 0
    s_sub_u32 s100, s100, 1
    s_cbranch_scc0 L_sp1
    s_endpgm
L_sp1d:
    ds_read_b64 v[84:85], v73 offset:0
    ds_read_b64 v[86:87], v73 offset:4096
    ds_read_b64 v[88:89], v73 offset:8192
    ds_read_b64 v[90:91], v73 offset:12288
    ds_read_b64 v[92:93], v73 offset:16384
    ds_read_b64 v[100:101], v73 offset:2048
    ds_read_b64 v[102:103], v73 offset:6144
    ds_read_b64 v[104:105], v73 offset:10240
    ds_read_b64 v[106:107], v73 offset:14336
    ds_read_b64 v[108:109], v73 offset:18432
    v_mov_b32 v150, v78
    v_mov_b32 v151, v79
    s_waitcnt lgkmcnt(5)
    v_pk_add_f32 v[84:85], v[84:85], v[86:87]
    v_pk_add_f32 v[88:89], v[88:89], v[90:91]
    v_pk_add_f32 v[84:85], v[84:85], v[92:93]
    v_pk_add_f32 v[76:77], v[84:85], v[88:89]
    buffer_store_dwordx4 v[76:79], v1, s[72:75], s70 offen sc1
    s_waitcnt lgkmcnt(0)
    v_pk_add_f32 v[100:101], v[100:101], v[102:103]
    v_pk_add_f32 v[104:105], v[104:105], v[106:107]
    v_pk_add_f32 v[100:101], v[100:101], v[108:109]
    v_pk_add_f32 v[148:149], v[100:101], v[104:105]
    buffer_store_dwordx4 v[148:151], v1, s[72:75], s71 offen sc1
    s_mov_b64 exec, 1
    ds_add_rtn_u32 v61, v82, v83 offset:4428
    s_mov_b64 exec, -1
    s_waitcnt lgkmcnt(0)
    v_readfirstlane_b32 s91, v61
    s_nop 0
    s_cmp_lg_u32 s91, 8
    s_cbranch_scc1 L_norel
    v_lshrrev_b32 v60, 4, v1
    v_add_u32 v61, 10, v60
    v_lshlrev_b32 v60, 2, v60
    s_mov_b64 exec, 7
    ds_write_b32 v60, v61 offset:4520
    s_mov_b64 exec, -1
L_norel:
    s_mov_b32 s99, 32768
    s_sleep 32
L_qchk:
    buffer_load_dwordx4 v[156:159], v74, s[72:75], s68 offen sc1
    buffer_load_dwordx4 v[160:163], v74, s[72:75], s69 offen sc1
    s_waitcnt vmcnt(0)
    v_xor_b32 v60, s80, v158
    v_xor_b32 v61, s81, v159
    v_xor_b32 v62, s80, v162
    v_xor_b32 v63, s81, v163
    v_or3_b32 v60, v60, v62, v63
    v_or_b32 v60, v60, v61
    v_cmp_ne_u32 vcc, 0, v60
    s_nop 4
    s_cbranch_vccz L_qok
    s_sleep 10
    s_sub_u32 s99, s99, 1
    s_cbranch_scc0 L_qchk
L_qok:
    v_permlane32_swap_b32 v156, v160
    v_permlane32_swap_b32 v157, v161
    v_add_f32 v156, v156, v160
    v_add_f32 v157, v157, v161
    s_nop 1
    v_permlane16_swap_b32 v156, v157
    v_add_f32 v156, v156, v157
    v_cvt_pk_bf16_f32 v156, v156, v156
    ds_write_b16 v75, v156 offset:4608
    s_waitcnt lgkmcnt(0)
    s_mov_b64 exec, 1
    ds_add_u32 v82, v83 offset:4432
    s_mov_b64 exec, -1
L_qwait:
    s_mov_b64 exec, 1
    ds_add_rtn_u32 v7, v82, v83 offset:4424
    s_mov_b64 exec, -1
L_sp2:
    ds_read_b32 v60, v82 offset:4432
    s_waitcnt lgkmcnt(0)
    v_readfirstlane_b32 s91, v60
    s_nop 0
    s_cmp_ge_u32 s91, 4
    s_cbranch_scc1 L_sp2d
    s_sleep 2
    s_sub_u32 s100, s100, 1
    s_cbranch_scc0 L_sp2
    s_endpgm
L_sp2d:
    s_waitcnt vmcnt(0)
    v_lshlrev_b32 v60, 4, v3
    ds_read_b128 v[48:51], v60 offset:4608
    v_mov_b32 v56, 0xff800000
    v_mov_b32 v58, 0
    v_mov_b32 v40, 0
    v_mov_b32 v41, 0
    v_mov_b32 v42, 0
    v_mov_b32 v43, 0
    v_mov_b32 v44, 0
    v_mov_b32 v45, 0
    v_mov_b32 v46, 0
    v_mov_b32 v47, 0
    s_mov_b32 s89, 0
    v_lshrrev_b32 v164, 6, v1
    v_lshlrev_b32 v164, 2, v164
    v_add_u32 v164, 9728, v164
L_cons:
    s_waitcnt lgkmcnt(0)
    v_readfirstlane_b32 s90, v7
    s_nop 0
    s_cmp_lt_u32 s90, 64
    s_cbranch_scc1 L_go
    s_cmp_eq_u32 s98, 0
    s_cbranch_scc1 L_deposit
    s_cmp_ge_u32 s90, 320
    s_cbranch_scc1 L_done
L_go:
    s_and_b32 s91, s90, 31
    s_cmp_eq_u32 s91, 22
    s_cbranch_scc1 L_ctl
L_ctl_ret:
    s_mul_i32 s92, s90, 5042
    s_lshr_b32 s92, s92, 16
    s_mul_i32 s92, s92, 13
    s_sub_u32 s92, s90, s92
    s_lshl_b32 s64, s92, 13
    s_add_u32 s64, s64, 52736
    v_add_u32 v6, s64, v1
    s_lshl_b32 s92, s92, 2
    s_add_u32 s65, s90, 13
    v_mov_b32 v74, s92
    v_mov_b32 v75, s65
L_wait:
    ds_read_b64 v[60:61], v82 offset:4416
    s_waitcnt lgkmcnt(0)
    v_readfirstlane_b32 s91, v60
    v_readfirstlane_b32 s92, v61
    s_cmp_gt_u32 s91, s90
    s_cbranch_scc1 L_have
    s_cmp_lt_u32 s48, 2
    s_cbranch_scc1 L_frag
    s_cmp_eq_u32 s90, -1
    s_cbranch_scc1 L_tfr_ok
L_nap:
    s_sleep 2
    s_sub_u32 s100, s100, 1
    s_cbranch_scc0 L_wait
    s_endpgm
L_have:
    s_and_b32 s91, s90, 31
    s_cbranch_scc0 L_mile
L_mret:
    ds_read_b128 v[8:11], v6 offset:0
    ds_read_b128 v[12:15], v6 offset:1024
    ds_read_b128 v[16:19], v6 offset:2048
    ds_read_b128 v[20:23], v6 offset:3072
    ds_read_b128 v[24:27], v6 offset:4096
    ds_read_b128 v[28:31], v6 offset:5120
    ds_read_b128 v[32:35], v6 offset:6144
    ds_read_b128 v[36:39], v6 offset:7168
    s_cmp_lt_u32 s90, 64
    s_cselect_b32 s91, 32, 192
    s_cselect_b32 s92, 0, 32
    s_cselect_b32 s65, 32, 160
    s_cmp_ge_u32 s90, s91
    s_cselect_b32 s92, s65, s92
    s_cselect_b32 s65, 1, 0
    s_sub_u32 s92, s90, s92
    s_lshl_b32 s92, s92, 6
    v_add_u32 v6, s92, v164
    s_cmp_eq_u32 s65, 1
    s_cbranch_scc1 L_vtask
    s_mov_b64 exec, 1
    ds_add_rtn_u32 v7, v82, v83 offset:4424
    s_mov_b64 exec, -1
    s_waitcnt lgkmcnt(8)
    v_dot2_f32_bf16 v60, v8, v48, 0
    v_dot2_f32_bf16 v60, v9, v49, v60
    v_dot2_f32_bf16 v60, v10, v50, v60
    v_dot2_f32_bf16 v60, v11, v51, v60
    s_waitcnt lgkmcnt(7)
    v_dot2_f32_bf16 v61, v12, v48, 0
    v_dot2_f32_bf16 v61, v13, v49, v61
    v_dot2_f32_bf16 v61, v14, v50, v61
    v_dot2_f32_bf16 v61, v15, v51, v61
    s_waitcnt lgkmcnt(6)
    v_dot2_f32_bf16 v62, v16, v48, 0
    v_dot2_f32_bf16 v62, v17, v49, v62
    v_dot2_f32_bf16 v62, v18, v50, v62
    v_dot2_f32_bf16 v62, v19, v51, v62
    s_waitcnt lgkmcnt(5)
    v_dot2_f32_bf16 v63, v20, v48, 0
    v_dot2_f32_bf16 v63, v21, v49, v63
    v_dot2_f32_bf16 v63, v22, v50, v63
    v_dot2_f32_bf16 v63, v23, v51, v63
    s_waitcnt lgkmcnt(4)
    v_dot2_f32_bf16 v64, v24, v48, 0
    v_dot2_f32_bf16 v64, v25, v49, v64
    v_dot2_f32_bf16 v64, v26, v50, v64
    v_dot2_f32_bf16 v64, v27, v51, v64
    s_waitcnt lgkmcnt(3)
    v_dot2_f32_bf16 v65, v28, v48, 0
    v_dot2_f32_bf16 v65, v29, v49, v65
    v_dot2_f32_bf16 v65, v30, v50, v65
    v_dot2_f32_bf16 v65, v31, v51, v65
    s_waitcnt lgkmcnt(2)
    v_dot2_f32_bf16 v66, v32, v48, 0
    v_dot2_f32_bf16 v66, v33, v49, v66
    v_dot2_f32_bf16 v66, v34, v50, v66
    v_dot2_f32_bf16 v66, v35, v51, v66
    s_waitcnt lgkmcnt(1)
    v_dot2_f32_bf16 v67, v36, v48, 0
    v_dot2_f32_bf16 v67, v37, v49, v67
    v_dot2_f32_bf16 v67, v38, v50, v67
    v_dot2_f32_bf16 v67, v39, v51, v67
    v_add_f32_dpp v52, v60, v60 row_ror:8 row_mask:0xf bank_mask:0x3
    v_add_f32_dpp v53, v62, v62 row_ror:8 row_mask:0xf bank_mask:0x3
    v_add_f32_dpp v54, v64, v64 row_ror:8 row_mask:0xf bank_mask:0x3
    v_add_f32_dpp v55, v66, v66 row_ror:8 row_mask:0xf bank_mask:0x3
    v_add_f32_dpp v52, v61, v61 row_ror:8 row_mask:0xf bank_mask:0xc
    v_add_f32_dpp v53, v63, v63 row_ror:8 row_mask:0xf bank_mask:0xc
    v_add_f32_dpp v54, v65, v65 row_ror:8 row_mask:0xf bank_mask:0xc
    v_add_f32_dpp v55, v67, v67 row_ror:8 row_mask:0xf bank_mask:0xc
    v_add_f32_dpp v68, v52, v52 row_half_mirror row_mask:0xf bank_mask:0x5
    v_add_f32_dpp v69, v54, v54 row_half_mirror row_mask:0xf bank_mask:0x5
    s_nop 0
    v_add_f32_dpp v68, v53, v53 row_half_mirror row_mask:0xf bank_mask:0xa
    v_add_f32_dpp v69, v55, v55 row_half_mirror row_mask:0xf bank_mask:0xa
    s_nop 0
    v_add_f32_dpp v68, v68, v68 quad_perm:[1,0,3,2] row_mask:0xf bank_mask:0xf
    v_add_f32_dpp v69, v69, v69 quad_perm:[1,0,3,2] row_mask:0xf bank_mask:0xf
    s_nop 0
    v_add_f32_dpp v68, v68, v68 quad_perm:[2,3,0,1] row_mask:0xf bank_mask:0xf
    v_add_f32_dpp v69, v69, v69 quad_perm:[2,3,0,1] row_mask:0xf bank_mask:0xf
    v_cvt_pk_bf16_f32 v60, v68, v69
    v_lshlrev_b32 v68, 16, v60
    v_and_b32 v69, s84, v60
    v_mul_f32 v68, s85, v68
    v_mul_f32 v69, s85, v69
    v_cvt_pk_bf16_f32 v60, v68, v69
    ds_write_b32 v6, v60
    ds_write_b32 v74, v75 offset:4480
    s_branch L_cons
L_vtask:
    ds_read_b32 v68, v6
    s_mov_b64 exec, 1
    ds_add_rtn_u32 v7, v82, v83 offset:4424
    s_mov_b64 exec, -1
    s_waitcnt lgkmcnt(1)
    ds_write_b32 v74, v75 offset:4480
    v_and_b32 v69, s84, v68
    v_lshlrev_b32 v68, 16, v68
    v_max_f32 v70, v68, v69
    v_perm_b32 v148, v12, v8, s87
    v_perm_b32 v149, v12, v8, s88
    v_max_f32_dpp v70, v70, v70 row_ror:4 row_mask:0xf bank_mask:0xf
    v_perm_b32 v150, v13, v9, s87
    v_perm_b32 v151, v13, v9, s88
    v_max_f32_dpp v70, v70, v70 row_ror:8 row_mask:0xf bank_mask:0xf
    v_max_f32 v70, v56, v70
    v_sub_f32 v68, v68, v70
    v_sub_f32 v69, v69, v70
    v_sub_f32 v59, v56, v70
    v_mul_f32 v68, s86, v68
    v_mul_f32 v69, s86, v69
    v_mul_f32 v59, s86, v59
    v_exp_f32 v68, v68
    v_exp_f32 v69, v69
    v_exp_f32 v59, v59
    v_mov_b32 v56, v70
    v_perm_b32 v152, v14, v10, s87
    v_perm_b32 v153, v14, v10, s88
    v_mov_b32_dpp v71, v68 row_ror:8 row_mask:0xf bank_mask:0xf
    v_mov_b32_dpp v72, v69 row_ror:8 row_mask:0xf bank_mask:0xf
    v_pk_mul_f32 v[40:41], v[40:41], v[58:59] op_sel:[0,1] op_sel_hi:[1,1]
    v_pk_mul_f32 v[42:43], v[42:43], v[58:59] op_sel:[0,1] op_sel_hi:[1,1]
    v_pk_mul_f32 v[44:45], v[44:45], v[58:59] op_sel:[0,1] op_sel_hi:[1,1]
    v_pk_mul_f32 v[46:47], v[46:47], v[58:59] op_sel:[0,1] op_sel_hi:[1,1]
    v_cvt_pk_bf16_f32 v71, v68, v71
    v_cvt_pk_bf16_f32 v72, v69, v72
    v_fma_f32 v58, v58, v59, v68
    v_perm_b32 v154, v15, v11, s87
    v_perm_b32 v155, v15, v11, s88
    v_perm_b32 v156, v20, v16, s87
    v_perm_b32 v157, v20, v16, s88
    v_perm_b32 v158, v21, v17, s87
    v_perm_b32 v159, v21, v17, s88
    v_perm_b32 v160, v22, v18, s87
    v_perm_b32 v161, v22, v18, s88
    v_perm_b32 v162, v23, v19, s87
    v_perm_b32 v163, v23, v19, s88
    v_add_f32 v58, v58, v69
    v_dot2c_f32_bf16_dpp v40, v71, v148 row_newbcast:0 row_mask:0xf bank_mask:0xf
    v_dot2c_f32_bf16_dpp v41, v71, v149 row_newbcast:0 row_mask:0xf bank_mask:0xf
    v_dot2c_f32_bf16_dpp v42, v71, v150 row_newbcast:0 row_mask:0xf bank_mask:0xf
    v_dot2c_f32_bf16_dpp v43, v71, v151 row_newbcast:0 row_mask:0xf bank_mask:0xf
    v_dot2c_f32_bf16_dpp v44, v71, v152 row_newbcast:0 row_mask:0xf bank_mask:0xf
    v_dot2c_f32_bf16_dpp v45, v71, v153 row_newbcast:0 row_mask:0xf bank_mask:0xf
    v_dot2c_f32_bf16_dpp v46, v71, v154 row_newbcast:0 row_mask:0xf bank_mask:0xf
    v_dot2c_f32_bf16_dpp v47, v71, v155 row_newbcast:0 row_mask:0xf bank_mask:0xf
    v_dot2c_f32_bf16_dpp v40, v71, v156 row_newbcast:4 row_mask:0xf bank_mask:0xf
    v_dot2c_f32_bf16_dpp v41, v71, v157 row_newbcast:4 row_mask:0xf bank_mask:0xf
    v_dot2c_f32_bf16_dpp v42, v71, v158 row_newbcast:4 row_mask:0xf bank_mask:0xf
    v_dot2c_f32_bf16_dpp v43, v71, v159 row_newbcast:4 row_mask:0xf bank_mask:0xf
    v_dot2c_f32_bf16_dpp v44, v71, v160 row_newbcast:4 row_mask:0xf bank_mask:0xf
    v_dot2c_f32_bf16_dpp v45, v71, v161 row_newbcast:4 row_mask:0xf bank_mask:0xf
    v_dot2c_f32_bf16_dpp v46, v71, v162 row_newbcast:4 row_mask:0xf bank_mask:0xf
    v_dot2c_f32_bf16_dpp v47, v71, v163 row_newbcast:4 row_mask:0xf bank_mask:0xf
    v_perm_b32 v148, v28, v24, s87
    v_perm_b32 v149, v28, v24, s88
    v_perm_b32 v150, v29, v25, s87
    v_perm_b32 v151, v29, v25, s88
    v_perm_b32 v152, v30, v26, s87
    v_perm_b32 v153, v30, v26, s88
    v_perm_b32 v154, v31, v27, s87
    v_perm_b32 v155, v31, v27, s88
    v_perm_b32 v156, v36, v32, s87
    v_perm_b32 v157, v36, v32, s88
    v_perm_b32 v158, v37, v33, s87
    v_perm_b32 v159, v37, v33, s88
    v_perm_b32 v160, v38, v34, s87
    v_perm_b32 v161, v38, v34, s88
    v_perm_b32 v162, v39, v35, s87
    v_perm_b32 v163, v39, v35, s88
    v_dot2c_f32_bf16_dpp v40, v72, v148 row_newbcast:0 row_mask:0xf bank_mask:0xf
    v_dot2c_f32_bf16_dpp v41, v72, v149 row_newbcast:0 row_mask:0xf bank_mask:0xf
    v_dot2c_f32_bf16_dpp v42, v72, v150 row_newbcast:0 row_mask:0xf bank_mask:0xf
    v_dot2c_f32_bf16_dpp v43, v72, v151 row_newbcast:0 row_mask:0xf bank_mask:0xf
    v_dot2c_f32_bf16_dpp v44, v72, v152 row_newbcast:0 row_mask:0xf bank_mask:0xf
    v_dot2c_f32_bf16_dpp v45, v72, v153 row_newbcast:0 row_mask:0xf bank_mask:0xf
    v_dot2c_f32_bf16_dpp v46, v72, v154 row_newbcast:0 row_mask:0xf bank_mask:0xf
    v_dot2c_f32_bf16_dpp v47, v72, v155 row_newbcast:0 row_mask:0xf bank_mask:0xf
    v_dot2c_f32_bf16_dpp v40, v72, v156 row_newbcast:4 row_mask:0xf bank_mask:0xf
    v_dot2c_f32_bf16_dpp v41, v72, v157 row_newbcast:4 row_mask:0xf bank_mask:0xf
    v_dot2c_f32_bf16_dpp v42, v72, v158 row_newbcast:4 row_mask:0xf bank_mask:0xf
    v_dot2c_f32_bf16_dpp v43, v72, v159 row_newbcast:4 row_mask:0xf bank_mask:0xf
    v_dot2c_f32_bf16_dpp v44, v72, v160 row_newbcast:4 row_mask:0xf bank_mask:0xf
    v_dot2c_f32_bf16_dpp v45, v72, v161 row_newbcast:4 row_mask:0xf bank_mask:0xf
    v_dot2c_f32_bf16_dpp v46, v72, v162 row_newbcast:4 row_mask:0xf bank_mask:0xf
    v_dot2c_f32_bf16_dpp v47, v72, v163 row_newbcast:4 row_mask:0xf bank_mask:0xf
    s_branch L_cons
L_mile:
    s_memrealtime s[96:97]
    s_mul_i32 s92, s90, 1024
    s_lshl_b32 s91, s2, 7
    s_add_u32 s92, s92, s91
    s_add_u32 s92, s92, 1048576
    s_and_b32 s91, s81, 0xffff0000
    s_waitcnt lgkmcnt(0)
    s_and_b32 s96, s96, 0xffff
    s_or_b32 s96, s96, s91
    v_mov_b32 v68, s96
    v_mov_b32 v69, s96
    v_mov_b32 v70, s96
    v_mov_b32 v71, s96
    s_mov_b64 exec, 0xff
    ds_write_b32 v82, v68 offset:4464
    buffer_store_dwordx4 v[68:71], v1, s[72:75], s92 offen sc1
    s_mov_b64 exec, -1
    s_waitcnt lgkmcnt(0)
    s_branch L_mret
L_ctl:
    s_cmp_lt_u32 s90, 32
    s_cbranch_scc1 L_ctl_ret
    s_andn2_b32 s92, s90, 31
    s_mul_i32 s92, s92, 1024
    s_andn2_b32 s91, s2, 31
    s_lshl_b32 s91, s91, 7
    s_add_u32 s92, s92, s91
    s_add_u32 s92, s92, 1048576
    s_add_u32 s68, s56, s92
    s_addc_u32 s69, s57, 0
    s_load_dword s4, s[68:69], 0
    s_load_dword s5, s[68:69], 128
    s_load_dword s6, s[68:69], 256
    s_load_dword s7, s[68:69], 384
    s_load_dword s8, s[68:69], 512
    s_load_dword s9, s[68:69], 640
    s_load_dword s10, s[68:69], 768
    s_load_dword s11, s[68:69], 896
    s_load_dword s12, s[68:69], 1024
    s_load_dword s13, s[68:69], 1152
    s_load_dword s14, s[68:69], 1280
    s_load_dword s15, s[68:69], 1408
    s_load_dword s16, s[68:69], 1536
    s_load_dword s17, s[68:69], 1664
    s_load_dword s18, s[68:69], 1792
    s_load_dword s19, s[68:69], 1920
    s_load_dword s32, s[68:69], 2048
    s_load_dword s33, s[68:69], 2176
    s_load_dword s34, s[68:69], 2304
    s_load_dword s35, s[68:69], 2432
    s_load_dword s36, s[68:69], 2560
    s_load_dword s37, s[68:69], 2688
    s_load_dword s38, s[68:69], 2816
    s_load_dword s39, s[68:69], 2944
    s_load_dword s40, s[68:69], 3072
    s_load_dword s41, s[68:69], 3200
    s_load_dword s42, s[68:69], 3328
    s_load_dword s43, s[68:69], 3456
    s_load_dword s44, s[68:69], 3584
    s_load_dword s45, s[68:69], 3712
    s_load_dword s46, s[68:69], 3840
    s_load_dword s47, s[68:69], 3968
    s_memrealtime s[96:97]
    ds_read_b32 v60, v82 offset:4464
    s_and_b32 s66, s81, 0xffff0000
    s_waitcnt lgkmcnt(0)
    v_readfirstlane_b32 s64, v60
    s_mov_b32 s65, 0
    s_and_b32 s91, s4, 0xffff0000
    s_cmp_eq_u32 s91, s66
    s_cselect_b32 s91, s4, s96
    s_sub_u32 s91, s91, s64
    s_sext_i32_i16 s91, s91
    s_add_i32 s65, s65, s91
    s_and_b32 s91, s5, 0xffff0000
    s_cmp_eq_u32 s91, s66
    s_cselect_b32 s91, s5, s96
    s_sub_u32 s91, s91, s64
    s_sext_i32_i16 s91, s91
    s_add_i32 s65, s65, s91
    s_and_b32 s91, s6, 0xffff0000
    s_cmp_eq_u32 s91, s66
    s_cselect_b32 s91, s6, s96
    s_sub_u32 s91, s91, s64
    s_sext_i32_i16 s91, s91
    s_add_i32 s65, s65, s91
    s_and_b32 s91, s7, 0xffff0000
    s_cmp_eq_u32 s91, s66
    s_cselect_b32 s91, s7, s96
    s_sub_u32 s91, s91, s64
    s_sext_i32_i16 s91, s91
    s_add_i32 s65, s65, s91
    s_and_b32 s91, s8, 0xffff0000
    s_cmp_eq_u32 s91, s66
    s_cselect_b32 s91, s8, s96
    s_sub_u32 s91, s91, s64
    s_sext_i32_i16 s91, s91
    s_add_i32 s65, s65, s91
    s_and_b32 s91, s9, 0xffff0000
    s_cmp_eq_u32 s91, s66
    s_cselect_b32 s91, s9, s96
    s_sub_u32 s91, s91, s64
    s_sext_i32_i16 s91, s91
    s_add_i32 s65, s65, s91
    s_and_b32 s91, s10, 0xffff0000
    s_cmp_eq_u32 s91, s66
    s_cselect_b32 s91, s10, s96
    s_sub_u32 s91, s91, s64
    s_sext_i32_i16 s91, s91
    s_add_i32 s65, s65, s91
    s_and_b32 s91, s11, 0xffff0000
    s_cmp_eq_u32 s91, s66
    s_cselect_b32 s91, s11, s96
    s_sub_u32 s91, s91, s64
    s_sext_i32_i16 s91, s91
    s_add_i32 s65, s65, s91
    s_and_b32 s91, s12, 0xffff0000
    s_cmp_eq_u32 s91, s66
    s_cselect_b32 s91, s12, s96
    s_sub_u32 s91, s91, s64
    s_sext_i32_i16 s91, s91
    s_add_i32 s65, s65, s91
    s_and_b32 s91, s13, 0xffff0000
    s_cmp_eq_u32 s91, s66
    s_cselect_b32 s91, s13, s96
    s_sub_u32 s91, s91, s64
    s_sext_i32_i16 s91, s91
    s_add_i32 s65, s65, s91
    s_and_b32 s91, s14, 0xffff0000
    s_cmp_eq_u32 s91, s66
    s_cselect_b32 s91, s14, s96
    s_sub_u32 s91, s91, s64
    s_sext_i32_i16 s91, s91
    s_add_i32 s65, s65, s91
    s_and_b32 s91, s15, 0xffff0000
    s_cmp_eq_u32 s91, s66
    s_cselect_b32 s91, s15, s96
    s_sub_u32 s91, s91, s64
    s_sext_i32_i16 s91, s91
    s_add_i32 s65, s65, s91
    s_and_b32 s91, s16, 0xffff0000
    s_cmp_eq_u32 s91, s66
    s_cselect_b32 s91, s16, s96
    s_sub_u32 s91, s91, s64
    s_sext_i32_i16 s91, s91
    s_add_i32 s65, s65, s91
    s_and_b32 s91, s17, 0xffff0000
    s_cmp_eq_u32 s91, s66
    s_cselect_b32 s91, s17, s96
    s_sub_u32 s91, s91, s64
    s_sext_i32_i16 s91, s91
    s_add_i32 s65, s65, s91
    s_and_b32 s91, s18, 0xffff0000
    s_cmp_eq_u32 s91, s66
    s_cselect_b32 s91, s18, s96
    s_sub_u32 s91, s91, s64
    s_sext_i32_i16 s91, s91
    s_add_i32 s65, s65, s91
    s_and_b32 s91, s19, 0xffff0000
    s_cmp_eq_u32 s91, s66
    s_cselect_b32 s91, s19, s96
    s_sub_u32 s91, s91, s64
    s_sext_i32_i16 s91, s91
    s_add_i32 s65, s65, s91
    s_and_b32 s91, s32, 0xffff0000
    s_cmp_eq_u32 s91, s66
    s_cselect_b32 s91, s32, s96
    s_sub_u32 s91, s91, s64
    s_sext_i32_i16 s91, s91
    s_add_i32 s65, s65, s91
    s_and_b32 s91, s33, 0xffff0000
    s_cmp_eq_u32 s91, s66
    s_cselect_b32 s91, s33, s96
    s_sub_u32 s91, s91, s64
    s_sext_i32_i16 s91, s91
    s_add_i32 s65, s65, s91
    s_and_b32 s91, s34, 0xffff0000
    s_cmp_eq_u32 s91, s66
    s_cselect_b32 s91, s34, s96
    s_sub_u32 s91, s91, s64
    s_sext_i32_i16 s91, s91
    s_add_i32 s65, s65, s91
    s_and_b32 s91, s35, 0xffff0000
    s_cmp_eq_u32 s91, s66
    s_cselect_b32 s91, s35, s96
    s_sub_u32 s91, s91, s64
    s_sext_i32_i16 s91, s91
    s_add_i32 s65, s65, s91
    s_and_b32 s91, s36, 0xffff0000
    s_cmp_eq_u32 s91, s66
    s_cselect_b32 s91, s36, s96
    s_sub_u32 s91, s91, s64
    s_sext_i32_i16 s91, s91
    s_add_i32 s65, s65, s91
    s_and_b32 s91, s37, 0xffff0000
    s_cmp_eq_u32 s91, s66
    s_cselect_b32 s91, s37, s96
    s_sub_u32 s91, s91, s64
    s_sext_i32_i16 s91, s91
    s_add_i32 s65, s65, s91
    s_and_b32 s91, s38, 0xffff0000
    s_cmp_eq_u32 s91, s66
    s_cselect_b32 s91, s38, s96
    s_sub_u32 s91, s91, s64
    s_sext_i32_i16 s91, s91
    s_add_i32 s65, s65, s91
    s_and_b32 s91, s39, 0xffff0000
    s_cmp_eq_u32 s91, s66
    s_cselect_b32 s91, s39, s96
    s_sub_u32 s91, s91, s64
    s_sext_i32_i16 s91, s91
    s_add_i32 s65, s65, s91
    s_and_b32 s91, s40, 0xffff0000
    s_cmp_eq_u32 s91, s66
    s_cselect_b32 s91, s40, s96
    s_sub_u32 s91, s91, s64
    s_sext_i32_i16 s91, s91
    s_add_i32 s65, s65, s91
    s_and_b32 s91, s41, 0xffff0000
    s_cmp_eq_u32 s91, s66
    s_cselect_b32 s91, s41, s96
    s_sub_u32 s91, s91, s64
    s_sext_i32_i16 s91, s91
    s_add_i32 s65, s65, s91
    s_and_b32 s91, s42, 0xffff0000
    s_cmp_eq_u32 s91, s66
    s_cselect_b32 s91, s42, s96
    s_sub_u32 s91, s91, s64
    s_sext_i32_i16 s91, s91
    s_add_i32 s65, s65, s91
    s_and_b32 s91, s43, 0xffff0000
    s_cmp_eq_u32 s91, s66
    s_cselect_b32 s91, s43, s96
    s_sub_u32 s91, s91, s64
    s_sext_i32_i16 s91, s91
    s_add_i32 s65, s65, s91
    s_and_b32 s91, s44, 0xffff0000
    s_cmp_eq_u32 s91, s66
    s_cselect_b32 s91, s44, s96
    s_sub_u32 s91, s91, s64
    s_sext_i32_i16 s91, s91
    s_add_i32 s65, s65, s91
    s_and_b32 s91, s45, 0xffff0000
    s_cmp_eq_u32 s91, s66
    s_cselect_b32 s91, s45, s96
    s_sub_u32 s91, s91, s64
    s_sext_i32_i16 s91, s91
    s_add_i32 s65, s65, s91
    s_and_b32 s91, s46, 0xffff0000
    s_cmp_eq_u32 s91, s66
    s_cselect_b32 s91, s46, s96
    s_sub_u32 s91, s91, s64
    s_sext_i32_i16 s91, s91
    s_add_i32 s65, s65, s91
    s_and_b32 s91, s47, 0xffff0000
    s_cmp_eq_u32 s91, s66
    s_cselect_b32 s91, s47, s96
    s_sub_u32 s91, s91, s64
    s_sext_i32_i16 s91, s91
    s_add_i32 s65, s65, s91
    s_ashr_i32 s65, s65, 5
    s_abs_i32 s91, s65
    s_cmp_gt_i32 s65, 0
    s_cselect_b32 s92, 0, 64
    s_cselect_b32 s65, 1, 0
    s_mul_i32 s92, s92, s91
    s_lshr_b32 s92, s92, 8
    s_min_u32 s92, s92, 32
    s_add_u32 s92, s92, s90
    s_lshl_b32 s92, s92, 1
    s_or_b32 s92, s92, s65
    s_cmp_lg_u32 s65, 0
    s_cselect_b32 s66, 80, 25
    s_cmp_gt_u32 s91, s66
    s_cselect_b32 s92, s92, 0
    s_cmp_lg_u32 s65, 0
    s_cselect_b32 s92, 0, s92
    v_mov_b32 v60, s92
    ds_write_b32 v82, v60 offset:4460
    s_branch L_ctl_ret
L_frag:
    s_cmp_eq_u32 s48, 0
    s_cselect_b32 s91, s54, 100
    s_cmp_lt_u32 s92, s91
    s_cbranch_scc1 L_nap
    v_lshlrev_b32 v60, 10, v4
    v_lshl_add_u32 v60, v2, 5, v60
    v_lshl_add_u32 v60, v3, 1, v60
    s_cmp_lg_u32 s48, 0
    s_cbranch_scc1 L_fragB
    ds_read_u16 v61, v60 offset:19968
    ds_read_u16 v62, v60 offset:20096
    ds_read_u16 v63, v60 offset:20224
    ds_read_u16 v64, v60 offset:20352
    ds_read_u16 v65, v60 offset:20480
    ds_read_u16 v66, v60 offset:20608
    ds_read_u16 v67, v60 offset:20736
    ds_read_u16 v68, v60 offset:20864
    s_waitcnt lgkmcnt(0)
    v_lshl_or_b32 v116, v62, 16, v61
    v_lshl_or_b32 v117, v64, 16, v63
    v_lshl_or_b32 v118, v66, 16, v65
    v_lshl_or_b32 v119, v68, 16, v67
    ds_read_u16 v61, v60 offset:24064
    ds_read_u16 v62, v60 offset:24192
    ds_read_u16 v63, v60 offset:24320
    ds_read_u16 v64, v60 offset:24448
    ds_read_u16 v65, v60 offset:24576
    ds_read_u16 v66, v60 offset:24704
    ds_read_u16 v67, v60 offset:24832
    ds_read_u16 v68, v60 offset:24960
    s_waitcnt lgkmcnt(0)
    v_lshl_or_b32 v120, v62, 16, v61
    v_lshl_or_b32 v121, v64, 16, v63
    v_lshl_or_b32 v122, v66, 16, v65
    v_lshl_or_b32 v123, v68, 16, v67
    ds_read_u16 v61, v60 offset:28160
    ds_read_u16 v62, v60 offset:28288
    ds_read_u16 v63, v60 offset:28416
    ds_read_u16 v64, v60 offset:28544
    ds_read_u16 v65, v60 offset:28672
    ds_read_u16 v66, v60 offset:28800
    ds_read_u16 v67, v60 offset:28928
    ds_read_u16 v68, v60 offset:29056
    s_waitcnt lgkmcnt(0)
    v_lshl_or_b32 v124, v62, 16, v61
    v_lshl_or_b32 v125, v64, 16, v63
    v_lshl_or_b32 v126, v66, 16, v65
    v_lshl_or_b32 v127, v68, 16, v67
    ds_read_u16 v61, v60 offset:32256
    ds_read_u16 v62, v60 offset:32384
    ds_read_u16 v63, v60 offset:32512
    ds_read_u16 v64, v60 offset:32640
    ds_read_u16 v65, v60 offset:32768
    ds_read_u16 v66, v60 offset:32896
    ds_read_u16 v67, v60 offset:33024
    ds_read_u16 v68, v60 offset:33152
    s_waitcnt lgkmcnt(0)
    v_lshl_or_b32 v128, v62, 16, v61
    v_lshl_or_b32 v129, v64, 16, v63
    v_lshl_or_b32 v130, v66, 16, v65
    v_lshl_or_b32 v131, v68, 16, v67
    ds_read_u16 v61, v60 offset:36352
    ds_read_u16 v62, v60 offset:36480
    ds_read_u16 v63, v60 offset:36608
    ds_read_u16 v64, v60 offset:36736
    ds_read_u16 v65, v60 offset:36864
    ds_read_u16 v66, v60 offset:36992
    ds_read_u16 v67, v60 offset:37120
    ds_read_u16 v68, v60 offset:37248
    s_waitcnt lgkmcnt(0)
    v_lshl_or_b32 v132, v62, 16, v61
    v_lshl_or_b32 v133, v64, 16, v63
    v_lshl_or_b32 v134, v66, 16, v65
    v_lshl_or_b32 v135, v68, 16, v67
    ds_read_u16 v61, v60 offset:40448
    ds_read_u16 v62, v60 offset:40576
    ds_read_u16 v63, v60 offset:40704
    ds_read_u16 v64, v60 offset:40832
    ds_read_u16 v65, v60 offset:40960
    ds_read_u16 v66, v60 offset:41088
    ds_read_u16 v67, v60 offset:41216
    ds_read_u16 v68, v60 offset:41344
    s_waitcnt lgkmcnt(0)
    v_lshl_or_b32 v136, v62, 16, v61
    v_lshl_or_b32 v137, v64, 16, v63
    v_lshl_or_b32 v138, v66, 16, v65
    v_lshl_or_b32 v139, v68, 16, v67
    ds_read_u16 v61, v60 offset:44544
    ds_read_u16 v62, v60 offset:44672
    ds_read_u16 v63, v60 offset:44800
    ds_read_u16 v64, v60 offset:44928
    ds_read_u16 v65, v60 offset:45056
    ds_read_u16 v66, v60 offset:45184
    ds_read_u16 v67, v60 offset:45312
    ds_read_u16 v68, v60 offset:45440
    s_waitcnt lgkmcnt(0)
    v_lshl_or_b32 v140, v62, 16, v61
    v_lshl_or_b32 v141, v64, 16, v63
    v_lshl_or_b32 v142, v66, 16, v65
    v_lshl_or_b32 v143, v68, 16, v67
    ds_read_u16 v61, v60 offset:48640
    ds_read_u16 v62, v60 offset:48768
    ds_read_u16 v63, v60 offset:48896
    ds_read_u16 v64, v60 offset:49024
    ds_read_u16 v65, v60 offset:49152
    ds_read_u16 v66, v60 offset:49280
    ds_read_u16 v67, v60 offset:49408
    ds_read_u16 v68, v60 offset:49536
    s_waitcnt lgkmcnt(0)
    v_lshl_or_b32 v144, v62, 16, v61
    v_lshl_or_b32 v145, v64, 16, v63
    v_lshl_or_b32 v146, v66, 16, v65
    v_lshl_or_b32 v147, v68, 16, v67
    s_mov_b64 exec, 1
    ds_add_u32 v82, v83 offset:4444
    s_mov_b64 exec, -1
    s_add_u32 s48, s48, 1
    s_branch L_wait
L_fragB:
    ds_read_u16 v61, v60 offset:19968
    ds_read_u16 v62, v60 offset:20096
    ds_read_u16 v63, v60 offset:20224
    ds_read_u16 v64, v60 offset:20352
    ds_read_u16 v65, v60 offset:20480
    ds_read_u16 v66, v60 offset:20608
    ds_read_u16 v67, v60 offset:20736
    ds_read_u16 v68, v60 offset:20864
    s_waitcnt lgkmcnt(0)
    v_lshl_or_b32 v84, v62, 16, v61
    v_lshl_or_b32 v85, v64, 16, v63
    v_lshl_or_b32 v86, v66, 16, v65
    v_lshl_or_b32 v87, v68, 16, v67
    ds_read_u16 v61, v60 offset:24064
    ds_read_u16 v62, v60 offset:24192
    ds_read_u16 v63, v60 offset:24320
    ds_read_u16 v64, v60 offset:24448
    ds_read_u16 v65, v60 offset:24576
    ds_read_u16 v66, v60 offset:24704
    ds_read_u16 v67, v60 offset:24832
    ds_read_u16 v68, v60 offset:24960
    s_waitcnt lgkmcnt(0)
    v_lshl_or_b32 v88, v62, 16, v61
    v_lshl_or_b32 v89, v64, 16, v63
    v_lshl_or_b32 v90, v66, 16, v65
    v_lshl_or_b32 v91, v68, 16, v67
    ds_read_u16 v61, v60 offset:28160
    ds_read_u16 v62, v60 offset:28288
    ds_read_u16 v63, v60 offset:28416
    ds_read_u16 v64, v60 offset:28544
    ds_read_u16 v65, v60 offset:28672
    ds_read_u16 v66, v60 offset:28800
    ds_read_u16 v67, v60 offset:28928
    ds_read_u16 v68, v60 offset:29056
    s_waitcnt lgkmcnt(0)
    v_lshl_or_b32 v92, v62, 16, v61
    v_lshl_or_b32 v93, v64, 16, v63
    v_lshl_or_b32 v94, v66, 16, v65
    v_lshl_or_b32 v95, v68, 16, v67
    ds_read_u16 v61, v60 offset:32256
    ds_read_u16 v62, v60 offset:32384
    ds_read_u16 v63, v60 offset:32512
    ds_read_u16 v64, v60 offset:32640
    ds_read_u16 v65, v60 offset:32768
    ds_read_u16 v66, v60 offset:32896
    ds_read_u16 v67, v60 offset:33024
    ds_read_u16 v68, v60 offset:33152
    s_waitcnt lgkmcnt(0)
    v_lshl_or_b32 v96, v62, 16, v61
    v_lshl_or_b32 v97, v64, 16, v63
    v_lshl_or_b32 v98, v66, 16, v65
    v_lshl_or_b32 v99, v68, 16, v67
    ds_read_u16 v61, v60 offset:36352
    ds_read_u16 v62, v60 offset:36480
    ds_read_u16 v63, v60 offset:36608
    ds_read_u16 v64, v60 offset:36736
    ds_read_u16 v65, v60 offset:36864
    ds_read_u16 v66, v60 offset:36992
    ds_read_u16 v67, v60 offset:37120
    ds_read_u16 v68, v60 offset:37248
    s_waitcnt lgkmcnt(0)
    v_lshl_or_b32 v100, v62, 16, v61
    v_lshl_or_b32 v101, v64, 16, v63
    v_lshl_or_b32 v102, v66, 16, v65
    v_lshl_or_b32 v103, v68, 16, v67
    ds_read_u16 v61, v60 offset:40448
    ds_read_u16 v62, v60 offset:40576
    ds_read_u16 v63, v60 offset:40704
    ds_read_u16 v64, v60 offset:40832
    ds_read_u16 v65, v60 offset:40960
    ds_read_u16 v66, v60 offset:41088
    ds_read_u16 v67, v60 offset:41216
    ds_read_u16 v68, v60 offset:41344
    s_waitcnt lgkmcnt(0)
    v_lshl_or_b32 v104, v62, 16, v61
    v_lshl_or_b32 v105, v64, 16, v63
    v_lshl_or_b32 v106, v66, 16, v65
    v_lshl_or_b32 v107, v68, 16, v67
    ds_read_u16 v61, v60 offset:44544
    ds_read_u16 v62, v60 offset:44672
    ds_read_u16 v63, v60 offset:44800
    ds_read_u16 v64, v60 offset:44928
    ds_read_u16 v65, v60 offset:45056
    ds_read_u16 v66, v60 offset:45184
    ds_read_u16 v67, v60 offset:45312
    ds_read_u16 v68, v60 offset:45440
    s_waitcnt lgkmcnt(0)
    v_lshl_or_b32 v108, v62, 16, v61
    v_lshl_or_b32 v109, v64, 16, v63
    v_lshl_or_b32 v110, v66, 16, v65
    v_lshl_or_b32 v111, v68, 16, v67
    ds_read_u16 v61, v60 offset:48640
    ds_read_u16 v62, v60 offset:48768
    ds_read_u16 v63, v60 offset:48896
    ds_read_u16 v64, v60 offset:49024
    ds_read_u16 v65, v60 offset:49152
    ds_read_u16 v66, v60 offset:49280
    ds_read_u16 v67, v60 offset:49408
    ds_read_u16 v68, v60 offset:49536
    s_waitcnt lgkmcnt(0)
    v_lshl_or_b32 v112, v62, 16, v61
    v_lshl_or_b32 v113, v64, 16, v63
    v_lshl_or_b32 v114, v66, 16, v65
    v_lshl_or_b32 v115, v68, 16, v67
    s_add_u32 s48, s48, 1
    s_branch L_wait
L_done:
L_deposit:
    v_max_f32 v57, 0xff7fffff, v56
    v_add_f32_dpp v58, v58, v58 row_ror:4 row_mask:0xf bank_mask:0xf
    v_mov_b32 v64, v57
    v_mov_b32 v65, v57
    v_add_f32_dpp v58, v58, v58 row_ror:8 row_mask:0xf bank_mask:0xf
    s_nop 0
    v_permlane32_swap_b32 v64, v65
    v_max_f32 v64, v64, v65
    v_mov_b32 v65, v64
    v_lshlrev_b32 v66, 3, v2
    s_nop 0
    v_permlane16_swap_b32 v64, v65
    v_max_f32 v64, v64, v65
    v_sub_f32 v59, v57, v64
    v_mul_f32 v59, s86, v59
    v_exp_f32 v59, v59
    s_lshl_b32 s92, s98, 2
    v_mov_b32 v68, s92
    s_mul_i32 s92, s98, 5120
    v_add_u32 v71, s92, v5
    v_add_u32 v66, s92, v66
    v_mov_b32 v72, s92
    v_pk_mul_f32 v[40:41], v[40:41], v[58:59] op_sel:[0,1] op_sel_hi:[1,1]
    v_pk_mul_f32 v[42:43], v[42:43], v[58:59] op_sel:[0,1] op_sel_hi:[1,1]
    v_pk_mul_f32 v[44:45], v[44:45], v[58:59] op_sel:[0,1] op_sel_hi:[1,1]
    v_pk_mul_f32 v[46:47], v[46:47], v[58:59] op_sel:[0,1] op_sel_hi:[1,1]
    v_mul_f32 v65, v59, v58
    v_mul_f32 v67, v59, v58
    v_permlane32_swap_b32 v40, v44
    v_permlane32_swap_b32 v41, v45
    v_permlane32_swap_b32 v42, v46
    v_permlane32_swap_b32 v43, v47
    v_permlane32_swap_b32 v65, v67
    v_add_f32 v40, v40, v44
    v_add_f32 v41, v41, v45
    v_add_f32 v42, v42, v46
    v_add_f32 v43, v43, v47
    v_add_f32 v65, v65, v67
    v_add_f32 v67, v65, v82
    v_permlane16_swap_b32 v40, v42
    v_permlane16_swap_b32 v41, v43
    v_permlane16_swap_b32 v65, v67
    v_add_f32 v40, v40, v42
    v_add_f32 v41, v41, v43
    v_add_f32 v65, v65, v67
    ds_write_b64 v71, v[40:41] offset:0
    ds_write_b64 v66, v[64:65] offset:4352
    s_mov_b64 exec, 1
    ds_add_rtn_u32 v69, v68, v83 offset:4436
    s_mov_b64 exec, -1
    s_lshl_b32 s68, s94, 13
    s_lshl_b32 s91, s98, 12
    s_add_u32 s68, s68, s91
    s_lshl_b32 s91, s93, 9
    s_add_u32 s68, s68, s91
    s_add_u32 s68, s68, 5242880
    v_lshrrev_b32 v70, 1, v1
    v_add_u32 v73, v70, v72
    s_waitcnt lgkmcnt(0)
    v_readfirstlane_b32 s91, v69
    s_nop 0
    s_cmp_lg_u32 s91, 6
    s_cbranch_scc1 L_dep_end
    ds_read_b64 v[24:25], v72 offset:4352
    ds_read_b64 v[26:27], v72 offset:4360
    ds_read_b64 v[28:29], v72 offset:4368
    ds_read_b64 v[30:31], v72 offset:4376
    ds_read_b64 v[32:33], v72 offset:4384
    ds_read_b64 v[34:35], v72 offset:4392
    ds_read_b64 v[36:37], v72 offset:4400
    ds_read_b64 v[8:9], v73 offset:0
    ds_read_b64 v[10:11], v73 offset:544
    ds_read_b64 v[12:13], v73 offset:1088
    ds_read_b64 v[14:15], v73 offset:1632
    ds_read_b64 v[16:17], v73 offset:2176
    ds_read_b64 v[18:19], v73 offset:2720
    ds_read_b64 v[20:21], v73 offset:3264
    s_waitcnt lgkmcnt(7)
    v_max3_f32 v60, v24, v26, v28
    v_max3_f32 v60, v60, v30, v32
    v_max3_f32 v60, v60, v34, v36
    v_sub_f32 v24, v24, v60
    v_sub_f32 v26, v26, v60
    v_sub_f32 v28, v28, v60
    v_sub_f32 v30, v30, v60
    v_sub_f32 v32, v32, v60
    v_sub_f32 v34, v34, v60
    v_sub_f32 v36, v36, v60
    v_mul_f32 v24, s86, v24
    v_mul_f32 v26, s86, v26
    v_mul_f32 v28, s86, v28
    v_mul_f32 v30, s86, v30
    v_mul_f32 v32, s86, v32
    v_mul_f32 v34, s86, v34
    v_mul_f32 v36, s86, v36
    v_exp_f32 v24, v24
    v_exp_f32 v26, v26
    v_exp_f32 v28, v28
    v_exp_f32 v30, v30
    v_exp_f32 v32, v32
    v_exp_f32 v34, v34
    v_exp_f32 v36, v36
    s_waitcnt lgkmcnt(0)
    v_mul_f32 v61, v24, v25
    v_pk_mul_f32 v[62:63], v[8:9], v[24:25] op_sel_hi:[1,0]
    v_fmac_f32 v61, v26, v27
    v_pk_fma_f32 v[62:63], v[10:11], v[26:27], v[62:63] op_sel_hi:[1,0,1]
    v_fmac_f32 v61, v28, v29
    v_pk_fma_f32 v[62:63], v[12:13], v[28:29], v[62:63] op_sel_hi:[1,0,1]
    v_fmac_f32 v61, v30, v31
    v_pk_fma_f32 v[62:63], v[14:15], v[30:31], v[62:63] op_sel_hi:[1,0,1]
    v_fmac_f32 v61, v32, v33
    v_pk_fma_f32 v[62:63], v[16:17], v[32:33], v[62:63] op_sel_hi:[1,0,1]
    v_fmac_f32 v61, v34, v35
    v_pk_fma_f32 v[62:63], v[18:19], v[34:35], v[62:63] op_sel_hi:[1,0,1]
    v_fmac_f32 v61, v36, v37
    v_pk_fma_f32 v[62:63], v[20:21], v[36:37], v[62:63] op_sel_hi:[1,0,1]
    v_rcp_f32 v61, v61
    s_nop 0
    v_mul_f32 v62, v62, v61
    v_mul_f32 v63, v63, v61
    v_cvt_pk_bf16_f32 v76, v62, v63
    s_nop 1
    v_mov_b32_dpp v77, v76 quad_perm:[1,0,3,2] row_mask:0xf bank_mask:0xf
    s_mov_b32 exec_lo, 0x55555555
    s_mov_b32 exec_hi, 0x55555555
    buffer_store_dwordx4 v[76:79], v70, s[72:75], s68 offen sc1
    s_mov_b64 exec, -1
L_dep_end:
    s_cmp_lg_u32 s98, 0
    s_cbranch_scc1 L_tail
    s_mov_b32 s98, 1
    v_lshlrev_b32 v60, 4, v3
    ds_read_b128 v[48:51], v60 offset:4864
    v_mov_b32 v56, 0xff800000
    v_mov_b32 v58, 0
    v_mov_b32 v40, 0
    v_mov_b32 v41, 0
    v_mov_b32 v42, 0
    v_mov_b32 v43, 0
    v_mov_b32 v44, 0
    v_mov_b32 v45, 0
    v_mov_b32 v46, 0
    v_mov_b32 v47, 0
    s_branch L_cons
L_tail:
    s_cmp_ge_u32 s3, 4
    s_cbranch_scc1 L_final
L_tfr:
    s_cmp_ge_u32 s48, 2
    s_cbranch_scc1 L_tfr_ok
    s_mov_b32 s90, -1
    s_branch L_wait
L_tfr_ok:
    v_and_b32 v68, 7, v3
    v_lshlrev_b32 v68, 7, v68
    v_lshl_add_u32 v68, v4, 5, v68
    v_and_b32 v69, 8, v3
    v_lshl_add_u32 v68, v69, 1, v68
    v_cmp_gt_u32 vcc, 8, v3
    s_mul_i32 s68, s94, 81920
    s_add_u32 s68, s68, 5767168
    s_lshl_b32 s92, s3, 10
    s_add_u32 s68, s68, s92
    s_lshl_b32 s92, s82, 12
    s_add_u32 s69, s68, s92
    s_lshl_b32 s92, s93, 12
    s_add_u32 s68, s68, s92
L_sp3:
    ds_read_b32 v60, v82 offset:4448
    s_waitcnt lgkmcnt(0)
    v_readfirstlane_b32 s91, v60
    s_nop 0
    s_cmp_ge_u32 s91, 1
    s_cbranch_scc1 L_sp3d
    s_sleep 1
    s_sub_u32 s100, s100, 1
    s_cbranch_scc0 L_sp3
    s_endpgm
L_sp3d:
    ds_read_b128 v[148:151], v81 offset:0
    ds_read_b128 v[152:155], v81 offset:64
    ds_read_b128 v[156:159], v81 offset:128
    ds_read_b128 v[160:163], v81 offset:192
    s_waitcnt lgkmcnt(3)
    v_mfma_f32_16x16x32_bf16 v[60:63], v[84:87], v[148:151], 0
    v_mfma_f32_16x16x32_bf16 v[64:67], v[100:103], v[148:151], 0
    s_waitcnt lgkmcnt(2)
    v_mfma_f32_16x16x32_bf16 v[60:63], v[88:91], v[152:155], v[60:63]
    v_mfma_f32_16x16x32_bf16 v[64:67], v[104:107], v[152:155], v[64:67]
    s_waitcnt lgkmcnt(1)
    v_mfma_f32_16x16x32_bf16 v[60:63], v[92:95], v[156:159], v[60:63]
    v_mfma_f32_16x16x32_bf16 v[64:67], v[108:111], v[156:159], v[64:67]
    s_waitcnt lgkmcnt(0)
    v_mfma_f32_16x16x32_bf16 v[60:63], v[96:99], v[160:163], v[60:63]
    v_mfma_f32_16x16x32_bf16 v[64:67], v[112:115], v[160:163], v[64:67]
    v_mov_b32 v10, v78
    v_mov_b32 v11, v79
    s_nop 4
    v_cndmask_b32 v76, v62, v60, vcc
    v_cndmask_b32 v77, v63, v61, vcc
    buffer_store_dwordx4 v[76:79], v68, s[72:75], s68 offen sc1
    s_cmp_lg_u32 s49, 4
    s_cbranch_scc1 L_nox0
    v_cndmask_b32 v8, v66, v64, vcc
    v_cndmask_b32 v9, v67, v65, vcc
    buffer_store_dwordx4 v[8:11], v68, s[72:75], s69 offen sc1
L_nox0:
    s_nop 1
    s_mul_i32 s68, s94, 81920
    s_add_u32 s68, s68, 5808128
    s_lshl_b32 s92, s3, 10
    s_add_u32 s68, s68, s92
    s_lshl_b32 s92, s83, 12
    s_add_u32 s69, s68, s92
    s_lshl_b32 s92, s93, 12
    s_add_u32 s68, s68, s92
L_sp4:
    ds_read_b32 v60, v82 offset:4448
    s_waitcnt lgkmcnt(0)
    v_readfirstlane_b32 s91, v60
    s_nop 0
    s_cmp_ge_u32 s91, 2
    s_cbranch_scc1 L_sp4d
    s_sleep 1
    s_sub_u32 s100, s100, 1
    s_cbranch_scc0 L_sp4
    s_endpgm
L_sp4d:
    ds_read_b128 v[148:151], v81 offset:2048
    ds_read_b128 v[152:155], v81 offset:2112
    ds_read_b128 v[156:159], v81 offset:2176
    ds_read_b128 v[160:163], v81 offset:2240
    s_waitcnt lgkmcnt(3)
    v_mfma_f32_16x16x32_bf16 v[60:63], v[116:119], v[148:151], 0
    v_mfma_f32_16x16x32_bf16 v[64:67], v[132:135], v[148:151], 0
    s_waitcnt lgkmcnt(2)
    v_mfma_f32_16x16x32_bf16 v[60:63], v[120:123], v[152:155], v[60:63]
    v_mfma_f32_16x16x32_bf16 v[64:67], v[136:139], v[152:155], v[64:67]
    s_waitcnt lgkmcnt(1)
    v_mfma_f32_16x16x32_bf16 v[60:63], v[124:127], v[156:159], v[60:63]
    v_mfma_f32_16x16x32_bf16 v[64:67], v[140:143], v[156:159], v[64:67]
    s_waitcnt lgkmcnt(0)
    v_mfma_f32_16x16x32_bf16 v[60:63], v[128:131], v[160:163], v[60:63]
    v_mfma_f32_16x16x32_bf16 v[64:67], v[144:147], v[160:163], v[64:67]
    v_mov_b32 v10, v78
    v_mov_b32 v11, v79
    s_nop 4
    v_cndmask_b32 v76, v62, v60, vcc
    v_cndmask_b32 v77, v63, v61, vcc
    buffer_store_dwordx4 v[76:79], v68, s[72:75], s68 offen sc1
    s_cmp_lg_u32 s54, 4
    s_cbranch_scc1 L_nox1
    v_cndmask_b32 v8, v66, v64, vcc
    v_cndmask_b32 v9, v67, v65, vcc
    buffer_store_dwordx4 v[8:11], v68, s[72:75], s69 offen sc1
L_nox1:
    s_nop 1
    s_branch L_fin_end
L_loader:
    s_setprio 3
    s_mov_b32 s67, s91
    s_add_u32 s4, s34, s91
    s_addc_u32 s5, s35, 0
    s_mov_b32 s90, 1
    s_mov_b32 s13, 60928
    s_sub_u32 s12, s12, 4096
    s_mov_b32 s14, 4
    s_mov_b32 s58, 4452
    s_mov_b32 s60, 4452
    s_mov_b32 s62, 4452
    s_mov_b32 s59, 0
    s_mov_b32 s61, 0
    s_mov_b32 s63, 0
    s_mov_b32 s72, s56
    s_mov_b32 s73, s57
    s_mov_b32 s74, 8388608
    s_mov_b32 s75, 0x00020000
    s_mov_b32 s76, s52
    s_mov_b32 s77, s53
    s_mov_b32 s78, 20480
    s_mov_b32 s79, 0x00020000
    s_cmp_lt_u32 s93, 2
    s_cselect_b32 s49, 4, 2
    s_sub_u32 s92, s93, 2
    s_cmp_lt_u32 s92, 2
    s_cselect_b32 s54, 4, 2
    s_add_u32 s82, s93, 8
    s_add_u32 s83, s93, 6
    v_lshrrev_b32 v6, 7, v1
    v_mul_u32_u24 v6, 1280, v6
    v_and_b32 v62, 0x70, v1
    v_add_u32 v6, v6, v62
    s_mul_i32 s92, s94, 163840
    s_add_u32 s28, s50, s92
    s_addc_u32 s29, s51, 0
    s_mov_b32 s30, 163840
    s_mov_b32 s31, 0x00020000
    s_lshl_b32 s64, s93, 7
    s_mov_b32 s68, 19968
    s_mov_b32 s48, 0
L_stg:
    s_add_u32 m0, s68, 0
    s_add_u32 s92, s64, 0
    s_waitcnt vmcnt(23)
    buffer_load_dwordx4 v6, s[28:31], s92 offen nt lds
    s_add_u32 m0, s68, 1024
    s_add_u32 s92, s64, 10240
    s_waitcnt vmcnt(23)
    buffer_load_dwordx4 v6, s[28:31], s92 offen nt lds
    s_add_u32 m0, s68, 2048
    s_add_u32 s92, s64, 20480
    s_waitcnt vmcnt(23)
    buffer_load_dwordx4 v6, s[28:31], s92 offen nt lds
    s_add_u32 m0, s68, 3072
    s_add_u32 s92, s64, 30720
    s_waitcnt vmcnt(23)
    buffer_load_dwordx4 v6, s[28:31], s92 offen nt lds
    s_add_u32 m0, s68, 4096
    s_add_u32 s92, s64, 40960
    s_waitcnt vmcnt(23)
    buffer_load_dwordx4 v6, s[28:31], s92 offen nt lds
    s_add_u32 m0, s68, 5120
    s_add_u32 s92, s64, 51200
    s_waitcnt vmcnt(23)
    buffer_load_dwordx4 v6, s[28:31], s92 offen nt lds
    s_add_u32 m0, s68, 6144
    s_add_u32 s92, s64, 61440
    s_waitcnt vmcnt(23)
    buffer_load_dwordx4 v6, s[28:31], s92 offen nt lds
    s_add_u32 m0, s68, 7168
    s_add_u32 s92, s64, 71680
    s_waitcnt vmcnt(23)
    buffer_load_dwordx4 v6, s[28:31], s92 offen nt lds
    s_add_u32 s48, s48, 1
    s_add_u32 s68, s68, 8192
    s_add_u32 s64, s64, 81920
    s_cmp_lg_u32 s48, 2
    s_cbranch_scc1 L_stg2
    s_lshl_b32 s64, s83, 7
L_stg2:
    s_cmp_lt_u32 s48, s54
    s_cbranch_scc1 L_stg
L_skv:
    s_add_u32 s90, s90, 1
    s_add_u32 s12, s12, 4096
    s_add_u32 s13, s13, 8192
    s_add_u32 s14, s14, 4
    s_add_u32 m0, s13, 0
    s_waitcnt vmcnt(23)
    buffer_load_dwordx4 v1, s[4:7], s12 offen offset:0 nt lds
    s_waitcnt vmcnt(23)
    buffer_load_dwordx4 v1, s[4:7], s12 offen offset:1024 nt lds
    s_waitcnt vmcnt(23)
    buffer_load_dwordx4 v1, s[4:7], s12 offen offset:2048 nt lds
    s_waitcnt vmcnt(23)
    buffer_load_dwordx4 v1, s[4:7], s12 offen offset:3072 nt lds
    s_add_u32 m0, s13, 4096
    s_waitcnt vmcnt(23)
    s_add_u32 s12, s12, 4096
    buffer_load_dwordx4 v1, s[4:7], s12 offen offset:0 nt lds
    s_waitcnt vmcnt(23)
    buffer_load_dwordx4 v1, s[4:7], s12 offen offset:1024 nt lds
    s_waitcnt vmcnt(23)
    buffer_load_dwordx4 v1, s[4:7], s12 offen offset:2048 nt lds
    s_waitcnt vmcnt(23)
    buffer_load_dwordx4 v1, s[4:7], s12 offen offset:3072 nt lds
    s_cmp_lt_u32 s90, 9
    s_cbranch_scc1 L_skv
    s_waitcnt vmcnt(16)
    s_mov_b32 s62, 4420
    v_mov_b32 v60, s62
    v_mov_b32 v61, s48
    s_mov_b64 exec, 1
    ds_max_u32 v60, v61
    s_mov_b64 exec, -1
    s_mov_b32 s62, 4416
    s_mov_b32 s63, 8
    v_mov_b32 v60, s62
    v_mov_b32 v61, s63
    s_mov_b64 exec, 1
    ds_max_u32 v60, v61
    s_mov_b64 exec, -1
    s_mov_b32 s60, 4416
    s_mov_b32 s61, 9
    s_mov_b32 s58, 4416
    s_mov_b32 s59, 10
    s_mov_b32 s101, 4452
    s_mov_b32 s90, 10
    s_add_u32 s12, s12, 4096
    s_add_u32 s13, s13, 8192
    s_add_u32 s14, s14, 4
    s_mov_b32 s15, 32
    v_mov_b32 v63, s14
L_lre:
    ds_read_b32 v64, v63 offset:4480
    ds_read_b32 v65, v82 offset:4460
    s_waitcnt lgkmcnt(0)
    v_readfirstlane_b32 s16, v64
    v_readfirstlane_b32 s17, v65
L_lloop:
    s_cmp_lt_u32 s16, s90
    s_cbranch_scc1 L_lfull
    s_lshr_b32 s92, s17, 1
    s_cmp_lt_u32 s90, s92
    s_cbranch_scc1 L_lspec
    s_add_u32 m0, s13, 0
    s_waitcnt vmcnt(19)
    buffer_load_dwordx4 v1, s[4:7], s12 offen offset:0 nt lds
    v_mov_b32 v60, s101
    v_mov_b32 v61, s95
    s_mov_b64 exec, 1
    ds_max_u32 v60, v61
    s_mov_b64 exec, -1
    s_add_u32 s14, s14, 4
    s_cmp_eq_u32 s14, 52
    s_cselect_b32 s14, 0, s14
    v_mov_b32 v63, s14
    s_waitcnt vmcnt(19)
    buffer_load_dwordx4 v1, s[4:7], s12 offen offset:1024 nt lds
    s_waitcnt vmcnt(19)
    buffer_load_dwordx4 v1, s[4:7], s12 offen offset:2048 nt lds
    s_waitcnt vmcnt(19)
    buffer_load_dwordx4 v1, s[4:7], s12 offen offset:3072 nt lds
    v_mov_b32 v60, s62
    v_mov_b32 v61, s63
    s_mov_b64 exec, 1
    ds_max_u32 v60, v61
    s_mov_b64 exec, -1
    s_add_u32 s12, s12, 4096
    s_add_u32 m0, s13, 4096
    s_waitcnt vmcnt(19)
    buffer_load_dwordx4 v1, s[4:7], s12 offen offset:0 nt lds
    s_add_u32 s13, s13, 8192
    s_cmp_eq_u32 s14, 0
    s_cselect_b32 s13, 52736, s13
    s_add_u32 s90, s90, 1
    s_waitcnt vmcnt(19)
    buffer_load_dwordx4 v1, s[4:7], s12 offen offset:1024 nt lds
    ds_read_b32 v64, v63 offset:4480
    ds_read_b32 v65, v82 offset:4460
    s_waitcnt vmcnt(19)
    buffer_load_dwordx4 v1, s[4:7], s12 offen offset:2048 nt lds
    s_waitcnt vmcnt(19)
    buffer_load_dwordx4 v1, s[4:7], s12 offen offset:3072 nt lds
    s_mov_b32 s101, s62
    s_mov_b32 s95, s63
    s_mov_b32 s62, s60
    s_mov_b32 s63, s61
    s_mov_b32 s60, s58
    s_mov_b32 s61, s59
    s_mov_b32 s58, 4416
    s_mov_b32 s59, s90
    s_add_u32 s12, s12, 4096
    s_waitcnt lgkmcnt(0)
    v_readfirstlane_b32 s16, v64
    v_readfirstlane_b32 s17, v65
L_lnext:
    s_cmp_lg_u32 s90, s15
    s_cbranch_scc1 L_lloop
    s_cmp_lg_u32 s90, 32
    s_cbranch_scc1 L_sw32
    s_add_u32 s4, s36, s67
    s_addc_u32 s5, s37, 0
    s_mov_b32 s6, 1048576
    s_mov_b32 s7, 0x00020000
    s_mov_b32 s12, 786432
    s_mov_b32 s15, 64
    s_branch L_lloop
L_sw32:
    s_cmp_lg_u32 s90, 64
    s_cbranch_scc1 L_sw64
    s_add_u32 s4, s44, s67
    s_addc_u32 s5, s45, 0
    s_mov_b32 s6, 1048576
    s_mov_b32 s7, 0x00020000
    s_mov_b32 s12, 0
    s_mov_b32 s15, 192
    s_branch L_lloop
L_sw64:
    s_cmp_lg_u32 s90, 192
    s_cbranch_scc1 L_sw192
    s_add_u32 s4, s46, s67
    s_addc_u32 s5, s47, 0
    s_mov_b32 s6, 1048576
    s_mov_b32 s7, 0x00020000
    s_mov_b32 s12, 0
    s_mov_b32 s15, 320
    s_branch L_lloop
L_sw192:
    s_branch L_lend
L_lfull:
    s_sleep 1
    s_sub_u32 s100, s100, 1
    s_cbranch_scc0 L_lre
    s_endpgm
L_lspec:
    s_add_u32 m0, s13, 0
    s_waitcnt vmcnt(31)
    buffer_load_dwordx4 v1, s[4:7], s12 offen offset:0 nt lds
    s_add_u32 s14, s14, 4
    s_cmp_eq_u32 s14, 52
    s_cselect_b32 s14, 0, s14
    v_mov_b32 v63, s14
    s_waitcnt vmcnt(31)
    buffer_load_dwordx4 v1, s[4:7], s12 offen offset:1024 nt lds
    s_waitcnt vmcnt(31)
    buffer_load_dwordx4 v1, s[4:7], s12 offen offset:2048 nt lds
    s_waitcnt vmcnt(31)
    buffer_load_dwordx4 v1, s[4:7], s12 offen offset:3072 nt lds
    s_add_u32 s12, s12, 4096
    s_add_u32 m0, s13, 4096
    s_waitcnt vmcnt(31)
    buffer_load_dwordx4 v1, s[4:7], s12 offen offset:0 nt lds
    s_add_u32 s13, s13, 8192
    s_cmp_eq_u32 s14, 0
    s_cselect_b32 s13, 52736, s13
    s_add_u32 s90, s90, 1
    s_waitcnt vmcnt(31)
    buffer_load_dwordx4 v1, s[4:7], s12 offen offset:1024 nt lds
    ds_read_b32 v64, v63 offset:4480
    ds_read_b32 v65, v82 offset:4460
    s_waitcnt vmcnt(31)
    buffer_load_dwordx4 v1, s[4:7], s12 offen offset:2048 nt lds
    s_waitcnt vmcnt(31)
    buffer_load_dwordx4 v1, s[4:7], s12 offen offset:3072 nt lds
    v_mov_b32 v60, s101
    v_mov_b32 v61, s95
    s_mov_b64 exec, 1
    ds_max_u32 v60, v61
    s_mov_b64 exec, -1
    s_mov_b32 s101, s62
    s_mov_b32 s95, s63
    s_mov_b32 s62, s60
    s_mov_b32 s63, s61
    s_mov_b32 s60, s58
    s_mov_b32 s61, s59
    s_mov_b32 s58, 4416
    s_mov_b32 s59, s90
    s_add_u32 s12, s12, 4096
    s_waitcnt lgkmcnt(0)
    v_readfirstlane_b32 s16, v64
    v_readfirstlane_b32 s17, v65
    s_branch L_lnext
L_lend:
L_sp5:
    ds_read_b32 v60, v82 offset:4444
    s_waitcnt lgkmcnt(0)
    v_readfirstlane_b32 s91, v60
    s_nop 0
    s_cmp_ge_u32 s91, 4
    s_cbranch_scc1 L_sp5d
    s_sleep 1
    s_sub_u32 s100, s100, 1
    s_cbranch_scc0 L_sp5
    s_endpgm
L_sp5d:
    s_waitcnt lgkmcnt(0)
    s_add_u32 s80, s80, 1
    s_mul_i32 s81, s80, 0x9e3779b1
    s_xor_b32 s81, s81, 0x5bd1e995
    v_mov_b32 v78, s80
    v_mov_b32 v79, s81
    s_mul_i32 s92, s94, 163840
    s_add_u32 s28, s40, s92
    s_addc_u32 s29, s41, 0
    s_mov_b32 s30, 163840
    s_mov_b32 s31, 0x00020000
    s_lshl_b32 s64, s93, 7
    s_lshl_b32 s65, s82, 7
    s_cmp_eq_u32 s49, 4
    s_cselect_b32 s65, s65, 0x100000
    s_mov_b32 s91, 4416
    s_mov_b32 s92, 317
    s_waitcnt vmcnt(24)
    v_mov_b32 v60, s91
    v_mov_b32 v61, s92
    s_mov_b64 exec, 1
    ds_max_u32 v60, v61
    s_mov_b64 exec, -1
    s_mov_b32 m0, 19968
    s_add_u32 s92, s64, 0
    buffer_load_dwordx4 v6, s[28:31], s92 offen nt lds
    s_mov_b32 m0, 20992
    s_add_u32 s92, s64, 10240
    buffer_load_dwordx4 v6, s[28:31], s92 offen nt lds
    s_mov_b32 m0, 22016
    s_add_u32 s92, s64, 20480
    buffer_load_dwordx4 v6, s[28:31], s92 offen nt lds
    s_mov_b32 m0, 23040
    s_add_u32 s92, s64, 30720
    buffer_load_dwordx4 v6, s[28:31], s92 offen nt lds
    s_mov_b32 m0, 24064
    s_add_u32 s92, s64, 40960
    buffer_load_dwordx4 v6, s[28:31], s92 offen nt lds
    s_mov_b32 m0, 25088
    s_add_u32 s92, s64, 51200
    buffer_load_dwordx4 v6, s[28:31], s92 offen nt lds
    s_mov_b32 m0, 26112
    s_add_u32 s92, s64, 61440
    buffer_load_dwordx4 v6, s[28:31], s92 offen nt lds
    s_mov_b32 m0, 27136
    s_add_u32 s92, s64, 71680
    buffer_load_dwordx4 v6, s[28:31], s92 offen nt lds
    s_mov_b32 s92, 318
    s_waitcnt vmcnt(24)
    v_mov_b32 v60, s91
    v_mov_b32 v61, s92
    s_mov_b64 exec, 1
    ds_max_u32 v60, v61
    s_mov_b64 exec, -1
    s_mov_b32 m0, 28160
    s_add_u32 s92, s64, 81920
    buffer_load_dwordx4 v6, s[28:31], s92 offen nt lds
    s_mov_b32 m0, 29184
    s_add_u32 s92, s64, 92160
    buffer_load_dwordx4 v6, s[28:31], s92 offen nt lds
    s_mov_b32 m0, 30208
    s_add_u32 s92, s64, 102400
    buffer_load_dwordx4 v6, s[28:31], s92 offen nt lds
    s_mov_b32 m0, 31232
    s_add_u32 s92, s64, 112640
    buffer_load_dwordx4 v6, s[28:31], s92 offen nt lds
    s_mov_b32 m0, 32256
    s_add_u32 s92, s64, 122880
    buffer_load_dwordx4 v6, s[28:31], s92 offen nt lds
    s_mov_b32 m0, 33280
    s_add_u32 s92, s64, 133120
    buffer_load_dwordx4 v6, s[28:31], s92 offen nt lds
    s_mov_b32 m0, 34304
    s_add_u32 s92, s64, 143360
    buffer_load_dwordx4 v6, s[28:31], s92 offen nt lds
    s_mov_b32 m0, 35328
    s_add_u32 s92, s64, 153600
    buffer_load_dwordx4 v6, s[28:31], s92 offen nt lds
    s_mov_b32 s92, 319
    s_waitcnt vmcnt(24)
    v_mov_b32 v60, s91
    v_mov_b32 v61, s92
    s_mov_b64 exec, 1
    ds_max_u32 v60, v61
    s_mov_b64 exec, -1
    s_mov_b32 m0, 36352
    s_add_u32 s92, s65, 0
    buffer_load_dwordx4 v6, s[28:31], s92 offen nt lds
    s_mov_b32 m0, 37376
    s_add_u32 s92, s65, 10240
    buffer_load_dwordx4 v6, s[28:31], s92 offen nt lds
    s_mov_b32 m0, 38400
    s_add_u32 s92, s65, 20480
    buffer_load_dwordx4 v6, s[28:31], s92 offen nt lds
    s_mov_b32 m0, 39424
    s_add_u32 s92, s65, 30720
    buffer_load_dwordx4 v6, s[28:31], s92 offen nt lds
    s_mov_b32 m0, 40448
    s_add_u32 s92, s65, 40960
    buffer_load_dwordx4 v6, s[28:31], s92 offen nt lds
    s_mov_b32 m0, 41472
    s_add_u32 s92, s65, 51200
    buffer_load_dwordx4 v6, s[28:31], s92 offen nt lds
    s_mov_b32 m0, 42496
    s_add_u32 s92, s65, 61440
    buffer_load_dwordx4 v6, s[28:31], s92 offen nt lds
    s_mov_b32 m0, 43520
    s_add_u32 s92, s65, 71680
    buffer_load_dwordx4 v6, s[28:31], s92 offen nt lds
    s_mov_b32 s92, 320
    s_waitcnt vmcnt(24)
    v_mov_b32 v60, s91
    v_mov_b32 v61, s92
    s_mov_b64 exec, 1
    ds_max_u32 v60, v61
    s_mov_b64 exec, -1
    s_mov_b32 m0, 44544
    s_add_u32 s92, s65, 81920
    buffer_load_dwordx4 v6, s[28:31], s92 offen nt lds
    s_mov_b32 m0, 45568
    s_add_u32 s92, s65, 92160
    buffer_load_dwordx4 v6, s[28:31], s92 offen nt lds
    s_mov_b32 m0, 46592
    s_add_u32 s92, s65, 102400
    buffer_load_dwordx4 v6, s[28:31], s92 offen nt lds
    s_mov_b32 m0, 47616
    s_add_u32 s92, s65, 112640
    buffer_load_dwordx4 v6, s[28:31], s92 offen nt lds
    s_mov_b32 m0, 48640
    s_add_u32 s92, s65, 122880
    buffer_load_dwordx4 v6, s[28:31], s92 offen nt lds
    s_mov_b32 m0, 49664
    s_add_u32 s92, s65, 133120
    buffer_load_dwordx4 v6, s[28:31], s92 offen nt lds
    s_mov_b32 m0, 50688
    s_add_u32 s92, s65, 143360
    buffer_load_dwordx4 v6, s[28:31], s92 offen nt lds
    s_mov_b32 m0, 51712
    s_add_u32 s92, s65, 153600
    buffer_load_dwordx4 v6, s[28:31], s92 offen nt lds
    s_lshl_b32 s68, s94, 13
    s_add_u32 s68, s68, 5242880
    buffer_load_dwordx4 v[148:151], v1, s[72:75], s68 offen offset:0 sc1
    buffer_load_dwordx4 v[152:155], v1, s[72:75], s68 offen offset:1024 sc1
    buffer_load_dwordx4 v[156:159], v1, s[72:75], s68 offen offset:2048 sc1
    buffer_load_dwordx4 v[160:163], v1, s[72:75], s68 offen offset:3072 sc1
    s_mov_b32 s91, 4420
    s_mov_b32 s92, 100
    s_waitcnt vmcnt(4)
    v_mov_b32 v60, s91
    v_mov_b32 v61, s92
    s_mov_b64 exec, 1
    ds_max_u32 v60, v61
    s_mov_b64 exec, -1
    s_setprio 0
    v_lshrrev_b32 v70, 1, v1
    s_mov_b32 s99, 32768
    s_branch L_op0w
L_op0:
    buffer_load_dwordx4 v[148:151], v1, s[72:75], s68 offen offset:0 sc1
    buffer_load_dwordx4 v[152:155], v1, s[72:75], s68 offen offset:1024 sc1
    buffer_load_dwordx4 v[156:159], v1, s[72:75], s68 offen offset:2048 sc1
    buffer_load_dwordx4 v[160:163], v1, s[72:75], s68 offen offset:3072 sc1
L_op0w:
    s_waitcnt vmcnt(0)
    v_xor_b32 v60, s80, v150
    v_xor_b32 v61, s81, v151
    v_xor_b32 v62, s80, v154
    v_xor_b32 v63, s81, v155
    v_or3_b32 v60, v60, v62, v63
    v_xor_b32 v62, s80, v158
    v_xor_b32 v63, s81, v159
    v_or3_b32 v60, v60, v62, v63
    v_xor_b32 v62, s80, v162
    v_xor_b32 v63, s81, v163
    v_or3_b32 v60, v60, v62, v63
    v_or_b32 v60, v60, v61
    v_cmp_ne_u32 vcc, 0, v60
    s_nop 4
    s_cbranch_vccz L_ok0
    s_sleep 1
    s_sub_u32 s99, s99, 1
    s_cbranch_scc0 L_op0
L_ok0:
    ds_write_b64 v70, v[148:149] offset:0
    ds_write_b64 v70, v[152:153] offset:512
    ds_write_b64 v70, v[156:157] offset:1024
    ds_write_b64 v70, v[160:161] offset:1536
    s_mov_b64 exec, 1
    ds_add_u32 v82, v83 offset:4448
    s_mov_b64 exec, -1
    s_add_u32 s68, s68, 4096
    s_mov_b32 s99, 32768
L_op1:
    buffer_load_dwordx4 v[148:151], v1, s[72:75], s68 offen offset:0 sc1
    buffer_load_dwordx4 v[152:155], v1, s[72:75], s68 offen offset:1024 sc1
    buffer_load_dwordx4 v[156:159], v1, s[72:75], s68 offen offset:2048 sc1
    buffer_load_dwordx4 v[160:163], v1, s[72:75], s68 offen offset:3072 sc1
    s_waitcnt vmcnt(0)
    v_xor_b32 v60, s80, v150
    v_xor_b32 v61, s81, v151
    v_xor_b32 v62, s80, v154
    v_xor_b32 v63, s81, v155
    v_or3_b32 v60, v60, v62, v63
    v_xor_b32 v62, s80, v158
    v_xor_b32 v63, s81, v159
    v_or3_b32 v60, v60, v62, v63
    v_xor_b32 v62, s80, v162
    v_xor_b32 v63, s81, v163
    v_or3_b32 v60, v60, v62, v63
    v_or_b32 v60, v60, v61
    v_cmp_ne_u32 vcc, 0, v60
    s_nop 4
    s_cbranch_vccz L_ok1
    s_sleep 1
    s_sub_u32 s99, s99, 1
    s_cbranch_scc0 L_op1
L_ok1:
    ds_write_b64 v70, v[148:149] offset:2048
    ds_write_b64 v70, v[152:153] offset:2560
    ds_write_b64 v70, v[156:157] offset:3072
    ds_write_b64 v70, v[160:161] offset:3584
    s_mov_b64 exec, 1
    ds_add_u32 v82, v83 offset:4448
    s_mov_b64 exec, -1
    s_branch L_fin_end
L_final:
    s_sub_u32 s91, s3, 4
    s_lshl_b32 s91, s91, 5
    s_add_u32 s91, s91, s94
    s_cmp_ge_u32 s91, 80
    s_cbranch_scc1 L_fin_end
    s_lshl_b32 s92, s91, 10
    s_lshl_b32 s68, s93, 7
    s_add_u32 s68, s68, s92
    s_add_u32 s68, s68, 5767168
    s_add_u32 s69, s68, 655360
    s_add_u32 s70, s68, 1310720
    s_add_u32 s71, s68, 1966080
    s_mul_i32 s64, s93, 2560
    s_lshl_b32 s91, s91, 5
    s_add_u32 s64, s64, s91
    v_lshrrev_b32 v68, 7, v1
    s_mov_b32 s91, 81920
    v_mul_lo_u32 v68, v68, s91
    v_and_b32 v69, 0x70, v1
    v_add_u32 v68, v68, v69
    v_lshrrev_b32 v69, 2, v69
L_sp6:
    ds_read_b32 v60, v82 offset:4448
    s_waitcnt lgkmcnt(0)
    v_readfirstlane_b32 s91, v60
    s_nop 0
    s_cmp_ge_u32 s91, 2
    s_cbranch_scc1 L_sp6d
    s_sleep 2
    s_sub_u32 s100, s100, 1
    s_cbranch_scc0 L_sp6
    s_endpgm
L_sp6d:
    s_mov_b32 s99, 32768
    s_sleep 28
L_poll:
    buffer_load_dwordx4 v[148:151], v68, s[72:75], s68 offen sc1
    buffer_load_dwordx4 v[152:155], v68, s[72:75], s69 offen sc1
    buffer_load_dwordx4 v[156:159], v68, s[72:75], s70 offen sc1
    buffer_load_dwordx4 v[160:163], v68, s[72:75], s71 offen sc1
    s_waitcnt vmcnt(0)
    v_xor_b32 v60, s80, v150
    v_xor_b32 v61, s81, v151
    v_xor_b32 v62, s80, v154
    v_xor_b32 v63, s81, v155
    v_or3_b32 v60, v60, v62, v63
    v_xor_b32 v62, s80, v158
    v_xor_b32 v63, s81, v159
    v_or3_b32 v60, v60, v62, v63
    v_xor_b32 v62, s80, v162
    v_xor_b32 v63, s81, v163
    v_or3_b32 v60, v60, v62, v63
    v_or_b32 v60, v60, v61
    v_cmp_ne_u32 vcc, 0, v60
    s_nop 4
    s_cbranch_vccz L_got
    s_sleep 4
    s_sub_u32 s99, s99, 1
    s_cbranch_scc0 L_poll
L_got:
    v_pk_add_f32 v[148:149], v[148:149], v[152:153]
    v_pk_add_f32 v[156:157], v[156:157], v[160:161]
    v_pk_add_f32 v[148:149], v[148:149], v[156:157]
    s_nop 1
    v_add_f32_dpp v148, v148, v148 row_ror:8 row_mask:0xf bank_mask:0xf
    v_add_f32_dpp v149, v149, v149 row_ror:8 row_mask:0xf bank_mask:0xf
    s_nop 1
    v_permlane32_swap_b32 v148, v149
    v_add_f32 v148, v148, v149
    v_mov_b32 v149, v148
    s_nop 1
    v_permlane16_swap_b32 v148, v149
    v_add_f32 v148, v148, v149
    v_mov_b32 v149, v148
    s_nop 1
    v_permlane32_swap_b32 v148, v149
    v_cvt_pk_bf16_f32 v148, v148, v149
    s_mov_b64 exec, 0xff
    buffer_store_dword v148, v69, s[76:79], s64 offen
    s_cmp_lg_u32 s2, 8
    s_cbranch_scc1 L_noep
    s_cmp_lg_u32 s3, 5
    s_cbranch_scc1 L_noep
    s_mov_b64 exec, 1
    buffer_store_dword v78, v82, s[72:75], 0 offen
L_noep:
    s_mov_b64 exec, -1
L_fin_end:
L_end:
    s_endpgm
.section .rodata,"a"
.p2align 6
.amdhsa_kernel concat_heads__sliding_block_cached__mha_block_cached__decode_kernel
  .amdhsa_next_free_vgpr 168
  .amdhsa_next_free_sgpr 102
  .amdhsa_accum_offset 168
  .amdhsa_group_segment_fixed_size 0
  .amdhsa_kernarg_size 104
  .amdhsa_user_sgpr_count 2
  .amdhsa_user_sgpr_kernarg_segment_ptr 1
  .amdhsa_system_sgpr_workgroup_id_x 1
.end_amdhsa_kernel
```
